```python
import torch

def _softmax(x, axis=-1):
    return torch.softmax(x, dim=axis)
def _gelu(x):
    return torch.nn.functional.gelu(x, approximate="tanh")
def _silu(x):
    return torch.nn.functional.silu(x)
def _sigmoid(x):
    return torch.sigmoid(x)
def _layernorm(x, axis=-1, eps=1e-5):
    m = x.mean(dim=axis, keepdim=True)
    v = x.var(dim=axis, keepdim=True, unbiased=False)
    return (x - m) / torch.sqrt(v + eps)
def _scatter_add(tgt, idx, src, axis=0):
    return tgt.clone().index_add_(axis, idx, src)
def _segment_sum(src, seg, n):
    out = torch.zeros((n,) + src.shape[1:], dtype=src.dtype)
    return out.index_add_(0, seg, src)
def _pad(x, pw):
    flat = tuple(v for pair in reversed(pw) for v in pair)
    return torch.nn.functional.pad(x, flat)

kernel_name = 'gated_mix__grouped_kv_mqa__dense_activation_relu__prompt'

def setup_inputs():

    _w = (lambda a: (lambda t: t.to(torch.bfloat16) if t.is_floating_point() else t)(torch.as_tensor(a)))
    def _A_setup():
        B, S, D, H = 1, 2048, 448, 16
        Dh = D // H
        return {
            "x": _w((lambda *s: torch.randn(*s, dtype=torch.bfloat16) * 0.05)(B, S, D)),
            "wq": _w((lambda *s: torch.randn(*s, dtype=torch.bfloat16) * 1.6)(D, H * Dh)),
            "wk": _w((lambda *s: torch.randn(*s, dtype=torch.bfloat16) * 1.6)(D, Dh)),
            "wv": _w((lambda *s: torch.randn(*s, dtype=torch.bfloat16) * 0.2)(D, Dh)),
            "wo": _w((lambda *s: torch.randn(*s, dtype=torch.bfloat16) * 0.2)(H * Dh, D)),
        }
    _A_in = _A_setup()

    def _B_setup():
        B, S, D, Dff = 1, 2048, 448, 1792
        return {
            "x": _w((lambda *s: torch.randn(*s, dtype=torch.bfloat16) * 0.05)(B, S, D)),
            "w1": _w((lambda *s: torch.randn(*s, dtype=torch.bfloat16) * 0.2)(D, Dff)),
            "w2": _w((lambda *s: torch.randn(*s, dtype=torch.bfloat16) * 0.2)(Dff, D)),
        }
    _B_in = _B_setup()

    return {
        "A_x": _A_in["x"],
        "A_wq": _A_in["wq"],
        "A_wk": _A_in["wk"],
        "A_wv": _A_in["wv"],
        "A_wo": _A_in["wo"],
        "B_x": _B_in["x"],
        "B_w1": _B_in["w1"],
        "B_w2": _B_in["w2"],
        "gate_w": _w((lambda *s: torch.randn(*s, dtype=torch.bfloat16) * 0.05)(448) * 16.0),
    }

def reference(A_x, A_wq, A_wk, A_wv, A_wo, B_x, B_w1, B_w2, gate_w):
    def _A_ref(x, wq, wk, wv, wo):
        B, S, D = x.shape
        H = 16
        Dh = D // H
        q = (lambda x, *d: x.permute(*d))((x @ wq).reshape(B, S, H, Dh), 0, 2, 1, 3)
        k = x @ wk
        v = x @ wv
        scores = torch.einsum("bhqd,bkd->bhqk", q, k) * (Dh ** -0.5)
        p = _softmax(scores, axis=-1)
        o = torch.einsum("bhqk,bkd->bhqd", p, v)
        return (lambda x, *d: x.permute(*d))(o, 0, 2, 1, 3).reshape(B, S, H * Dh) @ wo

    def _B_ref(x, w1, w2):
        h = torch.einsum("bsd,df->bsf", x, w1)
        zero = torch.zeros_like(h)
        h = torch.maximum(h, zero)
        return torch.einsum("bsf,fd->bsd", h, w2)

    x = A_x
    g = _sigmoid((x * gate_w).sum(-1, keepdims=True))
    a = _A_ref(x, A_wq, A_wk, A_wv, A_wo)
    b = _B_ref(x, B_w1, B_w2)
    return g * a + (1 - g) * b
```

```asm
; @launch grid=(256,1,1) block=(512,1,1) lds=163840
.amdgcn_target "amdgcn-amd-amdhsa--gfx950"
.text
.globl gated_mix__grouped_kv_mqa__dense_activation_relu__prompt_kernel
.p2align 8
.type gated_mix__grouped_kv_mqa__dense_activation_relu__prompt_kernel,@function
gated_mix__grouped_kv_mqa__dense_activation_relu__prompt_kernel:
    s_cmp_ge_u32 s2, 256
    s_cbranch_scc1 L_end
    s_load_dwordx16 s[40:55], s[0:1], 0
    s_load_dwordx8 s[56:63], s[0:1], 64
    v_mov_b32 v255, v0
    v_lshrrev_b32 v1, 6, v0
    v_and_b32 v0, 63, v0
    v_readfirstlane_b32 s68, v1
    s_and_b32 s75, s2, 7
    s_lshr_b32 s74, s2, 3
    s_lshr_b32 s69, s75, 1
    s_lshl_b32 s69, s69, 2
    s_lshr_b32 s76, s74, 3
    s_add_u32 s69, s69, s76
    s_and_b32 s70, s75, 1
    s_lshl_b32 s70, s70, 3
    s_and_b32 s76, s74, 7
    s_add_u32 s70, s70, s76
    s_mul_i32 s76, s74, 37
    s_lshr_b32 s76, s76, 8
    s_mul_i32 s77, s76, 7
    s_sub_u32 s72, s74, s77
    s_lshl_b32 s71, s75, 2
    s_add_u32 s71, s71, s76
    s_and_b32 s81, s74, 7
    s_lshr_b32 s76, s74, 3
    s_lshl_b32 s76, s76, 1
    s_add_u32 s81, s81, s76
    s_sub_u32 s76, s81, 7
    s_cselect_b32 s81, s81, s76
    s_mul_i32 s81, s81, 0
    s_mov_b32 s82, 0
    s_mov_b32 s83, -1
    s_cmp_ge_u32 s68, 4
    s_cbranch_scc1 L_ffn
    v_lshrrev_b32 v204, 4, v0
    v_bfe_u32 v205, v0, 2, 2
    v_lshl_add_u32 v206, v204, 3, v205
    v_mul_u32_u24 v200, 896, v206
    v_and_b32 v206, 1, v204
    v_lshlrev_b32 v206, 1, v206
    v_and_b32 v207, 3, v0
    v_xor_b32 v206, v206, v207
    v_lshl_add_u32 v200, v206, 4, v200
    s_mul_i32 s32, s68, 7
    s_mul_i32 s33, s70, 56
    s_mul_i32 s34, s68, 7168
    s_add_u32 s34, s34, 114688
    v_lshrrev_b32 v2, 4, v0
    v_and_b32 v11, 7, v0
    v_xor_b32 v11, v11, v2
    v_lshrrev_b32 v1, 3, v0
    v_mul_u32_u24 v1, 896, v1
    v_lshl_add_u32 v1, v11, 4, v1
    v_xor_b32 v15, 64, v1
    v_add_u32 v15, 7168, v15
    s_lshl_b32 s75, s69, 2
    s_add_u32 s78, s75, s68
    s_mul_i32 s75, s78, 28672
    s_lshl_b32 s77, s81, 7
    s_mul_i32 s80, s68, 28672
    s_waitcnt lgkmcnt(0)
    s_mov_b32 s8, s40
    s_and_b32 s9, s41, 0xffff
    s_mov_b32 s10, 1835008
    s_mov_b32 s11, 0x20000
    s_load_dword s73, s[62:63], 0
    s_mov_b32 s16, s42
    s_and_b32 s17, s43, 0xffff
    s_mov_b32 s18, 401408
    s_mov_b32 s19, 0x20000
    s_mov_b32 exec_lo, -1
    s_mov_b32 exec_hi, -1
    s_add_u32 s79, s32, 0
    s_and_b32 s35, s79, 1
    s_lshr_b32 s79, s79, 1
    s_lshl_b32 s79, s79, 3
    s_add_u32 s79, s79, s35
    s_mul_i32 s79, s79, 3584
    s_add_u32 m0, s34, 0
    s_add_u32 s79, s79, s33
    buffer_load_dwordx4 v200, s[16:19], s79 offen lds
    s_add_u32 s79, s32, 1
    s_and_b32 s35, s79, 1
    s_lshr_b32 s79, s79, 1
    s_lshl_b32 s79, s79, 3
    s_add_u32 s79, s79, s35
    s_mul_i32 s79, s79, 3584
    s_add_u32 m0, s34, 1024
    s_add_u32 s79, s79, s33
    buffer_load_dwordx4 v200, s[16:19], s79 offen lds
    s_add_u32 s79, s32, 2
    s_and_b32 s35, s79, 1
    s_lshr_b32 s79, s79, 1
    s_lshl_b32 s79, s79, 3
    s_add_u32 s79, s79, s35
    s_mul_i32 s79, s79, 3584
    s_add_u32 m0, s34, 2048
    s_add_u32 s79, s79, s33
    buffer_load_dwordx4 v200, s[16:19], s79 offen lds
    s_add_u32 s79, s32, 3
    s_and_b32 s35, s79, 1
    s_lshr_b32 s79, s79, 1
    s_lshl_b32 s79, s79, 3
    s_add_u32 s79, s79, s35
    s_mul_i32 s79, s79, 3584
    s_add_u32 m0, s34, 3072
    s_add_u32 s79, s79, s33
    buffer_load_dwordx4 v200, s[16:19], s79 offen lds
    s_add_u32 s79, s32, 4
    s_and_b32 s35, s79, 1
    s_lshr_b32 s79, s79, 1
    s_lshl_b32 s79, s79, 3
    s_add_u32 s79, s79, s35
    s_mul_i32 s79, s79, 3584
    s_add_u32 m0, s34, 4096
    s_add_u32 s79, s79, s33
    buffer_load_dwordx4 v200, s[16:19], s79 offen lds
    s_add_u32 s79, s32, 5
    s_and_b32 s35, s79, 1
    s_lshr_b32 s79, s79, 1
    s_lshl_b32 s79, s79, 3
    s_add_u32 s79, s79, s35
    s_mul_i32 s79, s79, 3584
    s_add_u32 m0, s34, 5120
    s_add_u32 s79, s79, s33
    buffer_load_dwordx4 v200, s[16:19], s79 offen lds
    s_add_u32 s79, s32, 6
    s_and_b32 s35, s79, 1
    s_lshr_b32 s79, s79, 1
    s_lshl_b32 s79, s79, 3
    s_add_u32 s79, s79, s35
    s_mul_i32 s79, s79, 3584
    s_add_u32 m0, s34, 6144
    s_add_u32 s79, s79, s33
    buffer_load_dwordx4 v200, s[16:19], s79 offen lds
    v_add_u32 v206, s32, v204
    v_lshrrev_b32 v201, 1, v206
    v_lshlrev_b32 v201, 5, v201
    v_and_b32 v206, 1, v206
    v_lshl_add_u32 v201, v206, 2, v201
    v_lshl_add_u32 v201, v205, 3, v201
    v_add_u32 v201, v201, v207
    v_add_u32 v202, 64, v201
    v_and_b32 v206, 1, v205
    v_lshlrev_b32 v206, 5, v206
    v_xor_b32 v206, 56, v206
    v_lshl_add_u32 v203, v0, 6, v206
    v_add_u32 v203, s34, v203
    s_cmp_eq_u32 s70, 14
    s_cbranch_scc1 L_exg
    s_cmp_ge_u32 s70, 7
    s_cbranch_scc1 L_exv
    s_mov_b32 s24, s44
    s_and_b32 s25, s45, 0xffff
    s_mov_b32 s26, 25088
    s_mov_b32 s27, 0x20000
    s_mov_b32 s33, s70
    v_mul_u32_u24 v201, 56, v201
    s_lshl_b32 s33, s33, 3
    v_mul_u32_u24 v202, 56, v202
    buffer_load_dwordx2 v[208:209], v201, s[24:27], s33 offen
    buffer_load_dwordx2 v[210:211], v202, s[24:27], s33 offen
    s_branch L_exd
L_exv:
    s_mov_b32 s24, s46
    s_and_b32 s25, s47, 0xffff
    s_mov_b32 s26, 25088
    s_mov_b32 s27, 0x20000
    s_cmp_eq_u32 s70, 15
    s_cselect_b32 s26, 0, s26
    s_sub_u32 s33, s70, 7
    v_mul_u32_u24 v201, 56, v201
    s_lshl_b32 s33, s33, 3
    v_mul_u32_u24 v202, 56, v202
    buffer_load_dwordx2 v[208:209], v201, s[24:27], s33 offen
    buffer_load_dwordx2 v[210:211], v202, s[24:27], s33 offen
    s_branch L_exd
L_exg:
    s_mov_b32 s24, s56
    s_and_b32 s25, s57, 0xffff
    s_mov_b32 s26, 896
    s_mov_b32 s27, 0x20000
    v_lshlrev_b32 v201, 1, v201
    v_lshlrev_b32 v202, 1, v202
    v_mov_b32 v209, 0
    v_mov_b32 v211, 0
    buffer_load_ushort v208, v201, s[24:27], 0 offen
    buffer_load_ushort v210, v202, s[24:27], 0 offen
L_exd:
    s_add_u32 m0, s80, 0
    s_add_u32 s76, s75, s77
    buffer_load_dwordx4 v1, s[8:11], s76 offen lds
    s_add_u32 m0, s80, 1024
    s_add_u32 s77, s77, 128
    buffer_load_dwordx4 v15, s[8:11], s76 offen lds
    s_add_u32 m0, s80, 2048
    s_add_u32 s76, s76, 14336
    buffer_load_dwordx4 v1, s[8:11], s76 offen lds
    s_add_u32 m0, s80, 3072
    s_cmp_eq_u32 s77, 896
    buffer_load_dwordx4 v15, s[8:11], s76 offen lds
    s_cselect_b32 s77, 0, s77
    s_add_u32 m0, s80, 4096
    s_add_u32 s76, s75, s77
    buffer_load_dwordx4 v1, s[8:11], s76 offen lds
    s_add_u32 m0, s80, 5120
    s_add_u32 s77, s77, 128
    buffer_load_dwordx4 v15, s[8:11], s76 offen lds
    s_add_u32 m0, s80, 6144
    s_add_u32 s76, s76, 14336
    buffer_load_dwordx4 v1, s[8:11], s76 offen lds
    s_add_u32 m0, s80, 7168
    s_cmp_eq_u32 s77, 896
    buffer_load_dwordx4 v15, s[8:11], s76 offen lds
    s_cselect_b32 s77, 0, s77
    s_add_u32 m0, s80, 8192
    s_add_u32 s76, s75, s77
    buffer_load_dwordx4 v1, s[8:11], s76 offen lds
    s_add_u32 m0, s80, 9216
    s_add_u32 s77, s77, 128
    buffer_load_dwordx4 v15, s[8:11], s76 offen lds
    s_add_u32 m0, s80, 10240
    s_add_u32 s76, s76, 14336
    buffer_load_dwordx4 v1, s[8:11], s76 offen lds
    s_add_u32 m0, s80, 11264
    s_cmp_eq_u32 s77, 896
    buffer_load_dwordx4 v15, s[8:11], s76 offen lds
    s_cselect_b32 s77, 0, s77
    s_add_u32 m0, s80, 12288
    s_add_u32 s76, s75, s77
    buffer_load_dwordx4 v1, s[8:11], s76 offen lds
    s_add_u32 m0, s80, 13312
    s_add_u32 s77, s77, 128
    buffer_load_dwordx4 v15, s[8:11], s76 offen lds
    s_add_u32 m0, s80, 14336
    s_add_u32 s76, s76, 14336
    buffer_load_dwordx4 v1, s[8:11], s76 offen lds
    s_add_u32 m0, s80, 15360
    s_cmp_eq_u32 s77, 896
    buffer_load_dwordx4 v15, s[8:11], s76 offen lds
    s_cselect_b32 s77, 0, s77
    s_add_u32 m0, s80, 16384
    s_add_u32 s76, s75, s77
    buffer_load_dwordx4 v1, s[8:11], s76 offen lds
    s_add_u32 m0, s80, 17408
    s_add_u32 s77, s77, 128
    buffer_load_dwordx4 v15, s[8:11], s76 offen lds
    s_add_u32 m0, s80, 18432
    s_add_u32 s76, s76, 14336
    buffer_load_dwordx4 v1, s[8:11], s76 offen lds
    s_add_u32 m0, s80, 19456
    s_cmp_eq_u32 s77, 896
    buffer_load_dwordx4 v15, s[8:11], s76 offen lds
    s_cselect_b32 s77, 0, s77
    s_add_u32 m0, s80, 20480
    s_add_u32 s76, s75, s77
    buffer_load_dwordx4 v1, s[8:11], s76 offen lds
    s_add_u32 m0, s80, 21504
    s_add_u32 s77, s77, 128
    buffer_load_dwordx4 v15, s[8:11], s76 offen lds
    s_add_u32 m0, s80, 22528
    s_add_u32 s76, s76, 14336
    buffer_load_dwordx4 v1, s[8:11], s76 offen lds
    s_add_u32 m0, s80, 23552
    s_cmp_eq_u32 s77, 896
    buffer_load_dwordx4 v15, s[8:11], s76 offen lds
    s_cselect_b32 s77, 0, s77
    s_add_u32 m0, s80, 24576
    s_add_u32 s76, s75, s77
    buffer_load_dwordx4 v1, s[8:11], s76 offen lds
    s_add_u32 m0, s80, 25600
    s_add_u32 s77, s77, 128
    buffer_load_dwordx4 v15, s[8:11], s76 offen lds
    s_add_u32 m0, s80, 26624
    s_add_u32 s76, s76, 14336
    buffer_load_dwordx4 v1, s[8:11], s76 offen lds
    s_add_u32 m0, s80, 27648
    s_cmp_eq_u32 s77, 896
    buffer_load_dwordx4 v15, s[8:11], s76 offen lds
    s_cselect_b32 s77, 0, s77
    s_mov_b32 s12, s62
    s_and_b32 s13, s63, 0xffff
    s_mov_b32 s14, 16777216
    s_mov_b32 s15, 0x20000
    s_mov_b32 s64, s62
    s_and_b32 s65, s63, 0xffff
    s_mov_b32 s66, 0
    s_mov_b32 s67, 0x20000
    s_lshl_b32 s75, s68, 16
    s_add_u32 s66, s75, 131072
    v_lshrrev_b32 v11, 2, v0
    v_and_b32 v12, 3, v0
    v_lshlrev_b32 v12, 3, v12
    v_lshl_add_u32 v3, v11, 6, v12
    v_and_b32 v13, 1, v2
    v_lshl_add_u32 v3, v13, 5, v3
    v_add_u32 v3, 114688, v3
    v_xor_b32 v4, 32, v3
    v_mul_u32_u24 v5, 224, v11
    v_add_u32 v5, v5, v12
    v_add_u32 v6, 57344, v5
    v_and_b32 v11, 15, v0
    v_mul_u32_u24 v7, 80, v11
    v_lshl_add_u32 v7, v2, 3, v7
    s_mul_i32 s75, s68, 2560
    s_add_u32 s75, s75, 153600
    v_add_u32 v7, s75, v7
    v_lshlrev_b32 v11, 4, v11
    v_lshl_add_u32 v8, v2, 9, v11
    v_lshrrev_b32 v12, 1, v2
    v_lshl_add_u32 v9, v12, 9, v11
    v_lshl_add_u32 v9, v13, 3, v9
    s_mov_b32 s77, 0x3e8b97f6
    v_mov_b32 v10, s77
    v_cmp_eq_u32 vcc, 3, v2
    s_mul_i32 s75, s78, 114688
    s_mul_i32 s76, s70, 7168
    v_cndmask_b32 v10, v10, 1.0, vcc
    s_add_u32 s75, s75, s76
    s_add_u32 s75, s75, 3145728
    s_add_u32 s76, s75, 4096
    s_waitcnt lgkmcnt(0)
    s_mul_i32 s3, s73, 0x9E3779B1
    s_add_u32 s3, s3, 0x7F4A7C15
    s_xor_b32 s73, s73, s3
    s_and_b32 s73, s73, 0x3fff0000
    s_cselect_b32 s73, 0, 0x10000
    s_xor_b32 s73, s73, s3
    v_and_b32 v11, 15, v0
    v_lshrrev_b32 v12, 1, v11
    v_xor_b32 v12, v12, v2
    v_lshlrev_b32 v12, 4, v12
    v_lshl_add_u32 v14, v11, 7, v12
    v_add_u32 v14, s80, v14
    v_xor_b32 v15, 64, v14
    s_waitcnt vmcnt(28)
    ds_write_b64 v203, v[208:209]
    s_mov_b32 exec_hi, 0xffff
    ds_write_b64 v203, v[210:211] offset:4096
    s_mov_b32 exec_hi, -1
    s_waitcnt vmcnt(26)
    ds_read_b128 v[16:19], v14 offset:0
    ds_read_b128 v[24:27], v15 offset:0
    s_waitcnt vmcnt(24)
    ds_read_b128 v[20:23], v14 offset:2048
    ds_read_b128 v[28:31], v15 offset:2048
    s_waitcnt vmcnt(22)
    ds_read_b128 v[32:35], v14 offset:4096
    ds_read_b128 v[40:43], v15 offset:4096
    s_waitcnt vmcnt(20)
    ds_read_b128 v[36:39], v14 offset:6144
    ds_read_b128 v[44:47], v15 offset:6144
    s_waitcnt vmcnt(18)
    ds_read_b128 v[48:51], v14 offset:8192
    ds_read_b128 v[56:59], v15 offset:8192
    s_waitcnt vmcnt(16) lgkmcnt(8)
    ds_read_b128 v[52:55], v14 offset:10240
    ds_read_b128 v[60:63], v15 offset:10240
    s_waitcnt vmcnt(14)
    ds_read_b128 v[64:67], v14 offset:12288
    ds_read_b128 v[72:75], v15 offset:12288
    s_waitcnt lgkmcnt(0)
    s_barrier
    s_waitcnt vmcnt(12)
    ds_read_b128 v[68:71], v14 offset:14336
    ds_read_b128 v[76:79], v15 offset:14336
    s_waitcnt vmcnt(10)
    ds_read_b128 v[80:83], v14 offset:16384
    ds_read_b128 v[88:91], v15 offset:16384
    s_waitcnt vmcnt(8)
    ds_read_b128 v[84:87], v14 offset:18432
    ds_read_b128 v[92:95], v15 offset:18432
    s_waitcnt vmcnt(6)
    ds_read_b128 v[96:99], v14 offset:20480
    ds_read_b128 v[104:107], v15 offset:20480
    s_waitcnt vmcnt(4)
    ds_read_b128 v[100:103], v14 offset:22528
    ds_read_b128 v[108:111], v15 offset:22528
    s_waitcnt vmcnt(2)
    ds_read_b128 v[112:115], v14 offset:24576
    ds_read_b128 v[120:123], v15 offset:24576
    s_waitcnt vmcnt(0)
    ds_read_b128 v[116:119], v14 offset:26624
    ds_read_b128 v[124:127], v15 offset:26624
    s_waitcnt lgkmcnt(2)
    ds_read_b64_tr_b16 v[128:129], v3 offset:0
    ds_read_b64_tr_b16 v[130:131], v3 offset:1024
    ds_read_b64_tr_b16 v[132:133], v4 offset:0
    ds_read_b64_tr_b16 v[134:135], v4 offset:1024
    ds_read_b64_tr_b16 v[136:137], v3 offset:2048
    ds_read_b64_tr_b16 v[138:139], v3 offset:3072
    ds_read_b64_tr_b16 v[140:141], v4 offset:2048
    ds_read_b64_tr_b16 v[142:143], v4 offset:3072
    ds_read_b64_tr_b16 v[144:145], v3 offset:4096
    ds_read_b64_tr_b16 v[146:147], v3 offset:5120
    ds_read_b64_tr_b16 v[148:149], v4 offset:4096
    ds_read_b64_tr_b16 v[150:151], v4 offset:5120
    s_waitcnt lgkmcnt(8)
    v_mfma_f32_16x16x32_bf16 v[160:163], v[128:131], v[16:19], 0
    ds_read_b64_tr_b16 v[152:153], v3 offset:6144
    v_mfma_f32_16x16x32_bf16 v[164:167], v[128:131], v[20:23], 0
    ds_read_b64_tr_b16 v[154:155], v3 offset:7168
    v_mfma_f32_16x16x32_bf16 v[168:171], v[132:135], v[16:19], 0
    ds_read_b64_tr_b16 v[156:157], v4 offset:6144
    v_mfma_f32_16x16x32_bf16 v[172:175], v[132:135], v[20:23], 0
    ds_read_b64_tr_b16 v[158:159], v4 offset:7168
    s_waitcnt lgkmcnt(8)
    v_mfma_f32_16x16x32_bf16 v[160:163], v[136:139], v[24:27], v[160:163]
    ds_read_b64_tr_b16 v[128:129], v3 offset:8192
    v_mfma_f32_16x16x32_bf16 v[164:167], v[136:139], v[28:31], v[164:167]
    ds_read_b64_tr_b16 v[130:131], v3 offset:9216
    v_mfma_f32_16x16x32_bf16 v[168:171], v[140:143], v[24:27], v[168:171]
    ds_read_b64_tr_b16 v[132:133], v4 offset:8192
    v_mfma_f32_16x16x32_bf16 v[172:175], v[140:143], v[28:31], v[172:175]
    ds_read_b64_tr_b16 v[134:135], v4 offset:9216
    s_waitcnt lgkmcnt(8)
    v_mfma_f32_16x16x32_bf16 v[160:163], v[144:147], v[32:35], v[160:163]
    ds_read_b64_tr_b16 v[136:137], v3 offset:10240
    v_mfma_f32_16x16x32_bf16 v[164:167], v[144:147], v[36:39], v[164:167]
    ds_read_b64_tr_b16 v[138:139], v3 offset:11264
    v_mfma_f32_16x16x32_bf16 v[168:171], v[148:151], v[32:35], v[168:171]
    ds_read_b64_tr_b16 v[140:141], v4 offset:10240
    v_mfma_f32_16x16x32_bf16 v[172:175], v[148:151], v[36:39], v[172:175]
    ds_read_b64_tr_b16 v[142:143], v4 offset:11264
    s_waitcnt lgkmcnt(8)
    v_mfma_f32_16x16x32_bf16 v[160:163], v[152:155], v[40:43], v[160:163]
    ds_read_b64_tr_b16 v[144:145], v3 offset:12288
    v_mfma_f32_16x16x32_bf16 v[164:167], v[152:155], v[44:47], v[164:167]
    ds_read_b64_tr_b16 v[146:147], v3 offset:13312
    v_mfma_f32_16x16x32_bf16 v[168:171], v[156:159], v[40:43], v[168:171]
    ds_read_b64_tr_b16 v[148:149], v4 offset:12288
    v_mfma_f32_16x16x32_bf16 v[172:175], v[156:159], v[44:47], v[172:175]
    ds_read_b64_tr_b16 v[150:151], v4 offset:13312
    s_waitcnt lgkmcnt(8)
    v_mfma_f32_16x16x32_bf16 v[160:163], v[128:131], v[48:51], v[160:163]
    ds_read_b64_tr_b16 v[152:153], v3 offset:14336
    v_mfma_f32_16x16x32_bf16 v[164:167], v[128:131], v[52:55], v[164:167]
    ds_read_b64_tr_b16 v[154:155], v3 offset:15360
    v_mfma_f32_16x16x32_bf16 v[168:171], v[132:135], v[48:51], v[168:171]
    ds_read_b64_tr_b16 v[156:157], v4 offset:14336
    v_mfma_f32_16x16x32_bf16 v[172:175], v[132:135], v[52:55], v[172:175]
    ds_read_b64_tr_b16 v[158:159], v4 offset:15360
    s_waitcnt lgkmcnt(8)
    v_mfma_f32_16x16x32_bf16 v[160:163], v[136:139], v[56:59], v[160:163]
    ds_read_b64_tr_b16 v[128:129], v3 offset:16384
    v_mfma_f32_16x16x32_bf16 v[164:167], v[136:139], v[60:63], v[164:167]
    ds_read_b64_tr_b16 v[130:131], v3 offset:17408
    v_mfma_f32_16x16x32_bf16 v[168:171], v[140:143], v[56:59], v[168:171]
    ds_read_b64_tr_b16 v[132:133], v4 offset:16384
    v_mfma_f32_16x16x32_bf16 v[172:175], v[140:143], v[60:63], v[172:175]
    ds_read_b64_tr_b16 v[134:135], v4 offset:17408
    s_waitcnt lgkmcnt(8)
    v_mfma_f32_16x16x32_bf16 v[160:163], v[144:147], v[64:67], v[160:163]
    ds_read_b64_tr_b16 v[136:137], v3 offset:18432
    v_mfma_f32_16x16x32_bf16 v[164:167], v[144:147], v[68:71], v[164:167]
    ds_read_b64_tr_b16 v[138:139], v3 offset:19456
    v_mfma_f32_16x16x32_bf16 v[168:171], v[148:151], v[64:67], v[168:171]
    ds_read_b64_tr_b16 v[140:141], v4 offset:18432
    v_mfma_f32_16x16x32_bf16 v[172:175], v[148:151], v[68:71], v[172:175]
    ds_read_b64_tr_b16 v[142:143], v4 offset:19456
    s_waitcnt lgkmcnt(8)
    v_mfma_f32_16x16x32_bf16 v[160:163], v[152:155], v[72:75], v[160:163]
    ds_read_b64_tr_b16 v[144:145], v3 offset:20480
    v_mfma_f32_16x16x32_bf16 v[164:167], v[152:155], v[76:79], v[164:167]
    ds_read_b64_tr_b16 v[146:147], v3 offset:21504
    v_mfma_f32_16x16x32_bf16 v[168:171], v[156:159], v[72:75], v[168:171]
    ds_read_b64_tr_b16 v[148:149], v4 offset:20480
    v_mfma_f32_16x16x32_bf16 v[172:175], v[156:159], v[76:79], v[172:175]
    ds_read_b64_tr_b16 v[150:151], v4 offset:21504
    s_waitcnt lgkmcnt(8)
    v_mfma_f32_16x16x32_bf16 v[160:163], v[128:131], v[80:83], v[160:163]
    ds_read_b64_tr_b16 v[152:153], v3 offset:22528
    v_mfma_f32_16x16x32_bf16 v[164:167], v[128:131], v[84:87], v[164:167]
    ds_read_b64_tr_b16 v[154:155], v3 offset:23552
    v_mfma_f32_16x16x32_bf16 v[168:171], v[132:135], v[80:83], v[168:171]
    ds_read_b64_tr_b16 v[156:157], v4 offset:22528
    v_mfma_f32_16x16x32_bf16 v[172:175], v[132:135], v[84:87], v[172:175]
    ds_read_b64_tr_b16 v[158:159], v4 offset:23552
    s_waitcnt lgkmcnt(8)
    v_mfma_f32_16x16x32_bf16 v[160:163], v[136:139], v[88:91], v[160:163]
    ds_read_b64_tr_b16 v[128:129], v3 offset:24576
    v_mfma_f32_16x16x32_bf16 v[164:167], v[136:139], v[92:95], v[164:167]
    ds_read_b64_tr_b16 v[130:131], v3 offset:25600
    v_mfma_f32_16x16x32_bf16 v[168:171], v[140:143], v[88:91], v[168:171]
    ds_read_b64_tr_b16 v[132:133], v4 offset:24576
    v_mfma_f32_16x16x32_bf16 v[172:175], v[140:143], v[92:95], v[172:175]
    ds_read_b64_tr_b16 v[134:135], v4 offset:25600
    s_waitcnt lgkmcnt(8)
    v_mfma_f32_16x16x32_bf16 v[160:163], v[144:147], v[96:99], v[160:163]
    ds_read_b64_tr_b16 v[136:137], v3 offset:26624
    v_mfma_f32_16x16x32_bf16 v[164:167], v[144:147], v[100:103], v[164:167]
    ds_read_b64_tr_b16 v[138:139], v3 offset:27648
    v_mfma_f32_16x16x32_bf16 v[168:171], v[148:151], v[96:99], v[168:171]
    ds_read_b64_tr_b16 v[140:141], v4 offset:26624
    v_mfma_f32_16x16x32_bf16 v[172:175], v[148:151], v[100:103], v[172:175]
    ds_read_b64_tr_b16 v[142:143], v4 offset:27648
    s_waitcnt lgkmcnt(8)
    v_mfma_f32_16x16x32_bf16 v[160:163], v[152:155], v[104:107], v[160:163]
    v_mfma_f32_16x16x32_bf16 v[164:167], v[152:155], v[108:111], v[164:167]
    v_mfma_f32_16x16x32_bf16 v[168:171], v[156:159], v[104:107], v[168:171]
    v_mfma_f32_16x16x32_bf16 v[172:175], v[156:159], v[108:111], v[172:175]
    s_waitcnt lgkmcnt(4)
    v_mfma_f32_16x16x32_bf16 v[160:163], v[128:131], v[112:115], v[160:163]
    v_mfma_f32_16x16x32_bf16 v[164:167], v[128:131], v[116:119], v[164:167]
    v_mfma_f32_16x16x32_bf16 v[168:171], v[132:135], v[112:115], v[168:171]
    v_mfma_f32_16x16x32_bf16 v[172:175], v[132:135], v[116:119], v[172:175]
    s_waitcnt lgkmcnt(0)
    v_mfma_f32_16x16x32_bf16 v[160:163], v[136:139], v[120:123], v[160:163]
    v_mfma_f32_16x16x32_bf16 v[164:167], v[136:139], v[124:127], v[164:167]
    v_mfma_f32_16x16x32_bf16 v[168:171], v[140:143], v[120:123], v[168:171]
    v_mfma_f32_16x16x32_bf16 v[172:175], v[140:143], v[124:127], v[172:175]
    s_nop 7
    v_mul_f32 v160, s77, v160
    v_mul_f32 v161, s77, v161
    v_mul_f32 v162, s77, v162
    v_mul_f32 v163, s77, v163
    v_mul_f32 v164, s77, v164
    v_mul_f32 v165, s77, v165
    v_mul_f32 v166, s77, v166
    v_mul_f32 v167, s77, v167
    v_mul_f32 v168, v10, v168
    v_mul_f32 v169, v10, v169
    v_mul_f32 v170, v10, v170
    v_mul_f32 v171, v10, v171
    v_mul_f32 v172, v10, v172
    v_mul_f32 v173, v10, v173
    v_mul_f32 v174, v10, v174
    v_mul_f32 v175, v10, v175
    v_cvt_pk_bf16_f32 v240, v160, v161
    v_cvt_pk_bf16_f32 v241, v162, v163
    v_cvt_pk_bf16_f32 v242, v164, v165
    v_cvt_pk_bf16_f32 v243, v166, v167
    v_cvt_pk_bf16_f32 v244, v168, v169
    v_cvt_pk_bf16_f32 v245, v170, v171
    v_cvt_pk_bf16_f32 v246, v172, v173
    v_cvt_pk_bf16_f32 v247, v174, v175
    ds_write_b64 v7, v[240:241] offset:0
    ds_write_b64 v7, v[242:243] offset:1280
    ds_write_b64 v7, v[244:245] offset:32
    ds_write_b64 v7, v[246:247] offset:1312
    s_waitcnt lgkmcnt(0)
    s_barrier
    ds_read_b64_tr_b16 v[128:129], v5 offset:0
    ds_read_b64_tr_b16 v[130:131], v5 offset:3584
    ds_read_b64_tr_b16 v[132:133], v5 offset:32
    ds_read_b64_tr_b16 v[134:135], v5 offset:3616
    ds_read_b64_tr_b16 v[136:137], v5 offset:28672
    ds_read_b64_tr_b16 v[138:139], v5 offset:32256
    ds_read_b64_tr_b16 v[140:141], v5 offset:28704
    ds_read_b64_tr_b16 v[142:143], v5 offset:32288
    ds_read_b64_tr_b16 v[144:145], v6 offset:0
    ds_read_b64_tr_b16 v[146:147], v6 offset:3584
    ds_read_b64_tr_b16 v[148:149], v6 offset:32
    ds_read_b64_tr_b16 v[150:151], v6 offset:3616
    s_waitcnt lgkmcnt(8)
    v_mfma_f32_16x16x32_bf16 v[168:171], v[128:131], v[16:19], 0
    ds_read_b64_tr_b16 v[152:153], v6 offset:28672
    v_mfma_f32_16x16x32_bf16 v[172:175], v[128:131], v[20:23], 0
    ds_read_b64_tr_b16 v[154:155], v6 offset:32256
    v_mfma_f32_16x16x32_bf16 v[176:179], v[132:135], v[16:19], 0
    ds_read_b64_tr_b16 v[156:157], v6 offset:28704
    v_mfma_f32_16x16x32_bf16 v[180:183], v[132:135], v[20:23], 0
    ds_read_b64_tr_b16 v[158:159], v6 offset:32288
    s_waitcnt lgkmcnt(8)
    v_mfma_f32_16x16x32_bf16 v[168:171], v[136:139], v[24:27], v[168:171]
    ds_read_b64_tr_b16 v[128:129], v5 offset:64
    v_and_b32 v11, 31, v0
    v_mfma_f32_16x16x32_bf16 v[172:175], v[136:139], v[28:31], v[172:175]
    ds_read_b64_tr_b16 v[130:131], v5 offset:3648
    v_lshrrev_b32 v12, 5, v0
    v_mfma_f32_16x16x32_bf16 v[176:179], v[140:143], v[24:27], v[176:179]
    ds_read_b64_tr_b16 v[132:133], v5 offset:96
    v_mul_u32_u24 v13, 80, v11
    v_mfma_f32_16x16x32_bf16 v[180:183], v[140:143], v[28:31], v[180:183]
    ds_read_b64_tr_b16 v[134:135], v5 offset:3680
    v_lshl_add_u32 v13, v12, 4, v13
    s_waitcnt lgkmcnt(8)
    v_mfma_f32_16x16x32_bf16 v[168:171], v[144:147], v[32:35], v[168:171]
    ds_read_b64_tr_b16 v[136:137], v5 offset:28736
    v_add_u32 v13, 153600, v13
    v_mfma_f32_16x16x32_bf16 v[172:175], v[144:147], v[36:39], v[172:175]
    ds_read_b64_tr_b16 v[138:139], v5 offset:32320
    v_lshlrev_b32 v1, 4, v0
    v_mfma_f32_16x16x32_bf16 v[176:179], v[148:151], v[32:35], v[176:179]
    ds_read_b64_tr_b16 v[140:141], v5 offset:28768
    v_lshlrev_b32 v11, 2, v11
    v_mfma_f32_16x16x32_bf16 v[180:183], v[148:151], v[36:39], v[180:183]
    ds_read_b64_tr_b16 v[142:143], v5 offset:32352
    s_lshl_b32 s77, s68, 16
    s_waitcnt lgkmcnt(8)
    v_mfma_f32_16x16x32_bf16 v[168:171], v[152:155], v[40:43], v[168:171]
    ds_read_b64_tr_b16 v[144:145], v6 offset:64
    s_add_u32 s77, s77, 65536
    v_mfma_f32_16x16x32_bf16 v[172:175], v[152:155], v[44:47], v[172:175]
    ds_read_b64_tr_b16 v[146:147], v6 offset:3648
    s_lshl_b32 s7, s78, 7
    v_mfma_f32_16x16x32_bf16 v[176:179], v[156:159], v[40:43], v[176:179]
    ds_read_b64_tr_b16 v[148:149], v6 offset:96
    s_add_u32 s7, s7, 16384
    v_mfma_f32_16x16x32_bf16 v[180:183], v[156:159], v[44:47], v[180:183]
    ds_read_b64_tr_b16 v[150:151], v6 offset:3680
    s_xor_b32 s79, s68, 3
    s_waitcnt lgkmcnt(8)
    v_mfma_f32_16x16x32_bf16 v[184:187], v[128:131], v[16:19], 0
    ds_read_b64_tr_b16 v[152:153], v6 offset:28736
    s_mul_i32 s4, s79, 28672
    v_mfma_f32_16x16x32_bf16 v[188:191], v[128:131], v[20:23], 0
    ds_read_b64_tr_b16 v[154:155], v6 offset:32320
    s_add_u32 s4, s4, 14336
    v_mfma_f32_16x16x32_bf16 v[192:195], v[132:135], v[16:19], 0
    ds_read_b64_tr_b16 v[156:157], v6 offset:28768
    v_add_u32 v2, s4, v1
    v_mfma_f32_16x16x32_bf16 v[196:199], v[132:135], v[20:23], 0
    ds_read_b64_tr_b16 v[158:159], v6 offset:32352
    s_waitcnt lgkmcnt(8)
    v_mfma_f32_16x16x32_bf16 v[184:187], v[136:139], v[24:27], v[184:187]
    ds_read_b64_tr_b16 v[128:129], v5 offset:128
    s_mul_i32 s4, s79, 2560
    v_mfma_f32_16x16x32_bf16 v[188:191], v[136:139], v[28:31], v[188:191]
    ds_read_b64_tr_b16 v[130:131], v5 offset:3712
    v_add_u32 v10, s4, v13
    v_mfma_f32_16x16x32_bf16 v[192:195], v[140:143], v[24:27], v[192:195]
    ds_read_b64_tr_b16 v[132:133], v5 offset:160
    s_xor_b32 s79, s68, 2
    v_mfma_f32_16x16x32_bf16 v[196:199], v[140:143], v[28:31], v[196:199]
    ds_read_b64_tr_b16 v[134:135], v5 offset:3744
    s_mul_i32 s4, s79, 28672
    s_waitcnt lgkmcnt(8)
    v_mfma_f32_16x16x32_bf16 v[184:187], v[144:147], v[32:35], v[184:187]
    ds_read_b64_tr_b16 v[136:137], v5 offset:28800
    s_add_u32 s4, s4, 18432
    v_mfma_f32_16x16x32_bf16 v[188:191], v[144:147], v[36:39], v[188:191]
    ds_read_b64_tr_b16 v[138:139], v5 offset:32384
    v_add_u32 v3, s4, v1
    v_mfma_f32_16x16x32_bf16 v[192:195], v[148:151], v[32:35], v[192:195]
    ds_read_b64_tr_b16 v[140:141], v5 offset:28832
    s_mul_i32 s4, s79, 2560
    v_mfma_f32_16x16x32_bf16 v[196:199], v[148:151], v[36:39], v[196:199]
    ds_read_b64_tr_b16 v[142:143], v5 offset:32416
    v_add_u32 v12, s4, v13
    s_waitcnt lgkmcnt(8)
    v_mfma_f32_16x16x32_bf16 v[184:187], v[152:155], v[40:43], v[184:187]
    ds_read_b64_tr_b16 v[144:145], v6 offset:128
    s_xor_b32 s79, s68, 1
    v_mfma_f32_16x16x32_bf16 v[188:191], v[152:155], v[44:47], v[188:191]
    ds_read_b64_tr_b16 v[146:147], v6 offset:3712
    s_mul_i32 s4, s79, 28672
    v_mfma_f32_16x16x32_bf16 v[192:195], v[156:159], v[40:43], v[192:195]
    ds_read_b64_tr_b16 v[148:149], v6 offset:160
    s_add_u32 s4, s4, 22528
    v_mfma_f32_16x16x32_bf16 v[196:199], v[156:159], v[44:47], v[196:199]
    ds_read_b64_tr_b16 v[150:151], v6 offset:3744
    v_add_u32 v4, s4, v1
    s_waitcnt lgkmcnt(8)
    v_mfma_f32_16x16x32_bf16 v[200:203], v[128:131], v[16:19], 0
    ds_read_b64_tr_b16 v[152:153], v6 offset:28800
    s_mul_i32 s4, s79, 2560
    v_mfma_f32_16x16x32_bf16 v[204:207], v[128:131], v[20:23], 0
    ds_read_b64_tr_b16 v[154:155], v6 offset:32384
    v_add_u32 v15, s4, v13
    v_mfma_f32_16x16x32_bf16 v[208:211], v[132:135], v[16:19], 0
    ds_read_b64_tr_b16 v[156:157], v6 offset:28832
    s_mul_i32 s4, s68, 28672
    v_mfma_f32_16x16x32_bf16 v[212:215], v[132:135], v[20:23], 0
    ds_read_b64_tr_b16 v[158:159], v6 offset:32416
    s_waitcnt lgkmcnt(8)
    v_mfma_f32_16x16x32_bf16 v[200:203], v[136:139], v[24:27], v[200:203]
    ds_read_b64_tr_b16 v[128:129], v5 offset:192
    s_add_u32 s4, s4, 14336
    v_mfma_f32_16x16x32_bf16 v[204:207], v[136:139], v[28:31], v[204:207]
    ds_read_b64_tr_b16 v[130:131], v5 offset:3776
    v_add_u32 v14, s4, v1
    v_mfma_f32_16x16x32_bf16 v[208:211], v[140:143], v[24:27], v[208:211]
    s_mul_i32 s4, s68, 2560
    v_mfma_f32_16x16x32_bf16 v[212:215], v[140:143], v[28:31], v[212:215]
    v_add_u32 v13, s4, v13
    s_waitcnt lgkmcnt(6)
    v_mfma_f32_16x16x32_bf16 v[200:203], v[144:147], v[32:35], v[200:203]
    ds_read_b64_tr_b16 v[136:137], v5 offset:28864
    s_lshl_b32 s6, s78, 4
    v_mfma_f32_16x16x32_bf16 v[204:207], v[144:147], v[36:39], v[204:207]
    ds_read_b64_tr_b16 v[138:139], v5 offset:32448
    s_add_u32 s6, s6, s70
    v_mfma_f32_16x16x32_bf16 v[208:211], v[148:151], v[32:35], v[208:211]
    s_lshl_b32 s4, s6, 7
    v_mfma_f32_16x16x32_bf16 v[212:215], v[148:151], v[36:39], v[212:215]
    s_add_u32 s81, s4, 2621440
    s_waitcnt lgkmcnt(4)
    v_mfma_f32_16x16x32_bf16 v[200:203], v[152:155], v[40:43], v[200:203]
    ds_read_b64_tr_b16 v[144:145], v6 offset:192
    s_lshl_b32 s6, s6, 11
    v_mfma_f32_16x16x32_bf16 v[204:207], v[152:155], v[44:47], v[204:207]
    ds_read_b64_tr_b16 v[146:147], v6 offset:3776
    s_add_u32 s6, s6, 524288
    v_mfma_f32_16x16x32_bf16 v[208:211], v[156:159], v[40:43], v[208:211]
    s_and_b32 s3, s73, 0xbfff0000
    v_mfma_f32_16x16x32_bf16 v[212:215], v[156:159], v[44:47], v[212:215]
    s_lshl_b32 s4, s68, 13
    s_waitcnt lgkmcnt(4)
    v_mfma_f32_16x16x32_bf16 v[160:163], v[128:131], v[16:19], 0
    ds_read_b64_tr_b16 v[152:153], v6 offset:28864
    s_add_u32 s4, s4, 114688
    v_add_u32 v7, s4, v1
    v_mfma_f32_16x16x32_bf16 v[164:167], v[128:131], v[20:23], 0
    ds_read_b64_tr_b16 v[154:155], v6 offset:32448
    s_mov_b32 s80, 0
    s_waitcnt lgkmcnt(4)
    v_mfma_f32_16x16x32_bf16 v[160:163], v[136:139], v[24:27], v[160:163]
    s_barrier
    ds_read_b64_tr_b16 v[128:129], v5 offset:7168
    ds_read_b64_tr_b16 v[130:131], v5 offset:10752
    v_mfma_f32_16x16x32_bf16 v[164:167], v[136:139], v[28:31], v[164:167]
    ds_read_b64_tr_b16 v[132:133], v5 offset:7200
    ds_read_b64_tr_b16 v[134:135], v5 offset:10784
    s_waitcnt lgkmcnt(6)
    v_mfma_f32_16x16x32_bf16 v[160:163], v[144:147], v[32:35], v[160:163]
    ds_read_b64_tr_b16 v[136:137], v5 offset:35840
    ds_read_b64_tr_b16 v[138:139], v5 offset:39424
    v_mfma_f32_16x16x32_bf16 v[164:167], v[144:147], v[36:39], v[164:167]
    ds_read_b64_tr_b16 v[140:141], v5 offset:35872
    ds_read_b64_tr_b16 v[142:143], v5 offset:39456
    s_waitcnt lgkmcnt(8)
    v_mfma_f32_16x16x32_bf16 v[160:163], v[152:155], v[40:43], v[160:163]
    ds_read_b64_tr_b16 v[144:145], v6 offset:7168
    ds_read_b64_tr_b16 v[146:147], v6 offset:10752
    v_mfma_f32_16x16x32_bf16 v[164:167], v[152:155], v[44:47], v[164:167]
    ds_read_b64_tr_b16 v[148:149], v6 offset:7200
    ds_read_b64_tr_b16 v[150:151], v6 offset:10784
    s_waitcnt lgkmcnt(8)
    v_mfma_f32_16x16x32_bf16 v[168:171], v[128:131], v[48:51], v[168:171]
    ds_read_b64_tr_b16 v[152:153], v6 offset:35840
    v_mfma_f32_16x16x32_bf16 v[172:175], v[128:131], v[52:55], v[172:175]
    ds_read_b64_tr_b16 v[154:155], v6 offset:39424
    v_mfma_f32_16x16x32_bf16 v[176:179], v[132:135], v[48:51], v[176:179]
    ds_read_b64_tr_b16 v[156:157], v6 offset:35872
    v_mfma_f32_16x16x32_bf16 v[180:183], v[132:135], v[52:55], v[180:183]
    ds_read_b64_tr_b16 v[158:159], v6 offset:39456
    s_waitcnt lgkmcnt(8)
    v_mfma_f32_16x16x32_bf16 v[168:171], v[136:139], v[56:59], v[168:171]
    ds_read_b64_tr_b16 v[128:129], v5 offset:7232
    v_mov_b32 v252, 0xdddddddd
    v_mfma_f32_16x16x32_bf16 v[172:175], v[136:139], v[60:63], v[172:175]
    ds_read_b64_tr_b16 v[130:131], v5 offset:10816
    v_mov_b32 v232, 0
    v_mfma_f32_16x16x32_bf16 v[176:179], v[140:143], v[56:59], v[176:179]
    ds_read_b64_tr_b16 v[132:133], v5 offset:7264
    v_mov_b32 v233, 0
    v_mfma_f32_16x16x32_bf16 v[180:183], v[140:143], v[60:63], v[180:183]
    ds_read_b64_tr_b16 v[134:135], v5 offset:10848
    v_mov_b32 v234, 0
    s_waitcnt lgkmcnt(8)
    v_mfma_f32_16x16x32_bf16 v[168:171], v[144:147], v[64:67], v[168:171]
    ds_read_b64_tr_b16 v[136:137], v5 offset:35904
    v_mov_b32 v235, 0
    v_mfma_f32_16x16x32_bf16 v[172:175], v[144:147], v[68:71], v[172:175]
    ds_read_b64_tr_b16 v[138:139], v5 offset:39488
    v_mov_b32 v236, 0
    v_mfma_f32_16x16x32_bf16 v[176:179], v[148:151], v[64:67], v[176:179]
    ds_read_b64_tr_b16 v[140:141], v5 offset:35936
    v_mov_b32 v237, 0
    v_mfma_f32_16x16x32_bf16 v[180:183], v[148:151], v[68:71], v[180:183]
    ds_read_b64_tr_b16 v[142:143], v5 offset:39520
    v_mov_b32 v238, 0
    s_waitcnt lgkmcnt(8)
    v_mfma_f32_16x16x32_bf16 v[168:171], v[152:155], v[72:75], v[168:171]
    ds_read_b64_tr_b16 v[144:145], v6 offset:7232
    v_mov_b32 v239, 0
    v_mfma_f32_16x16x32_bf16 v[172:175], v[152:155], v[76:79], v[172:175]
    ds_read_b64_tr_b16 v[146:147], v6 offset:10816
    v_mfma_f32_16x16x32_bf16 v[176:179], v[156:159], v[72:75], v[176:179]
    ds_read_b64_tr_b16 v[148:149], v6 offset:7264
    v_mfma_f32_16x16x32_bf16 v[180:183], v[156:159], v[76:79], v[180:183]
    ds_read_b64_tr_b16 v[150:151], v6 offset:10848
    s_waitcnt lgkmcnt(8)
    v_mfma_f32_16x16x32_bf16 v[184:187], v[128:131], v[48:51], v[184:187]
    ds_read_b64_tr_b16 v[152:153], v6 offset:35904
    v_mfma_f32_16x16x32_bf16 v[188:191], v[128:131], v[52:55], v[188:191]
    ds_read_b64_tr_b16 v[154:155], v6 offset:39488
    v_mfma_f32_16x16x32_bf16 v[192:195], v[132:135], v[48:51], v[192:195]
    ds_read_b64_tr_b16 v[156:157], v6 offset:35936
    v_mfma_f32_16x16x32_bf16 v[196:199], v[132:135], v[52:55], v[196:199]
    ds_read_b64_tr_b16 v[158:159], v6 offset:39520
    s_waitcnt lgkmcnt(8)
    v_mfma_f32_16x16x32_bf16 v[184:187], v[136:139], v[56:59], v[184:187]
    ds_read_b64_tr_b16 v[128:129], v5 offset:7296
    v_mfma_f32_16x16x32_bf16 v[188:191], v[136:139], v[60:63], v[188:191]
    ds_read_b64_tr_b16 v[130:131], v5 offset:10880
    v_mfma_f32_16x16x32_bf16 v[192:195], v[140:143], v[56:59], v[192:195]
    ds_read_b64_tr_b16 v[132:133], v5 offset:7328
    v_mfma_f32_16x16x32_bf16 v[196:199], v[140:143], v[60:63], v[196:199]
    ds_read_b64_tr_b16 v[134:135], v5 offset:10912
    s_waitcnt lgkmcnt(8)
    v_mfma_f32_16x16x32_bf16 v[184:187], v[144:147], v[64:67], v[184:187]
    ds_read_b64_tr_b16 v[136:137], v5 offset:35968
    v_mfma_f32_16x16x32_bf16 v[188:191], v[144:147], v[68:71], v[188:191]
    ds_read_b64_tr_b16 v[138:139], v5 offset:39552
    v_mfma_f32_16x16x32_bf16 v[192:195], v[148:151], v[64:67], v[192:195]
    ds_read_b64_tr_b16 v[140:141], v5 offset:36000
    v_mfma_f32_16x16x32_bf16 v[196:199], v[148:151], v[68:71], v[196:199]
    ds_read_b64_tr_b16 v[142:143], v5 offset:39584
    s_waitcnt lgkmcnt(8)
    v_mfma_f32_16x16x32_bf16 v[184:187], v[152:155], v[72:75], v[184:187]
    ds_read_b64_tr_b16 v[144:145], v6 offset:7296
    v_mfma_f32_16x16x32_bf16 v[188:191], v[152:155], v[76:79], v[188:191]
    ds_read_b64_tr_b16 v[146:147], v6 offset:10880
    v_mfma_f32_16x16x32_bf16 v[192:195], v[156:159], v[72:75], v[192:195]
    ds_read_b64_tr_b16 v[148:149], v6 offset:7328
    v_mfma_f32_16x16x32_bf16 v[196:199], v[156:159], v[76:79], v[196:199]
    ds_read_b64_tr_b16 v[150:151], v6 offset:10912
    s_waitcnt lgkmcnt(8)
    v_mfma_f32_16x16x32_bf16 v[200:203], v[128:131], v[48:51], v[200:203]
    ds_read_b64_tr_b16 v[152:153], v6 offset:35968
    v_mfma_f32_16x16x32_bf16 v[204:207], v[128:131], v[52:55], v[204:207]
    ds_read_b64_tr_b16 v[154:155], v6 offset:39552
    v_mfma_f32_16x16x32_bf16 v[208:211], v[132:135], v[48:51], v[208:211]
    ds_read_b64_tr_b16 v[156:157], v6 offset:36000
    v_mfma_f32_16x16x32_bf16 v[212:215], v[132:135], v[52:55], v[212:215]
    ds_read_b64_tr_b16 v[158:159], v6 offset:39584
    s_waitcnt lgkmcnt(8)
    v_mfma_f32_16x16x32_bf16 v[200:203], v[136:139], v[56:59], v[200:203]
    ds_read_b64_tr_b16 v[128:129], v5 offset:7360
    v_mfma_f32_16x16x32_bf16 v[204:207], v[136:139], v[60:63], v[204:207]
    ds_read_b64_tr_b16 v[130:131], v5 offset:10944
    v_mfma_f32_16x16x32_bf16 v[208:211], v[140:143], v[56:59], v[208:211]
    v_mfma_f32_16x16x32_bf16 v[212:215], v[140:143], v[60:63], v[212:215]
    s_waitcnt lgkmcnt(6)
    v_mfma_f32_16x16x32_bf16 v[200:203], v[144:147], v[64:67], v[200:203]
    ds_read_b64_tr_b16 v[136:137], v5 offset:36032
    v_mfma_f32_16x16x32_bf16 v[204:207], v[144:147], v[68:71], v[204:207]
    ds_read_b64_tr_b16 v[138:139], v5 offset:39616
    v_mfma_f32_16x16x32_bf16 v[208:211], v[148:151], v[64:67], v[208:211]
    v_mfma_f32_16x16x32_bf16 v[212:215], v[148:151], v[68:71], v[212:215]
    s_waitcnt lgkmcnt(4)
    v_mfma_f32_16x16x32_bf16 v[200:203], v[152:155], v[72:75], v[200:203]
    ds_read_b64_tr_b16 v[144:145], v6 offset:7360
    v_mfma_f32_16x16x32_bf16 v[204:207], v[152:155], v[76:79], v[204:207]
    ds_read_b64_tr_b16 v[146:147], v6 offset:10944
    v_mfma_f32_16x16x32_bf16 v[208:211], v[156:159], v[72:75], v[208:211]
    v_mfma_f32_16x16x32_bf16 v[212:215], v[156:159], v[76:79], v[212:215]
    s_waitcnt lgkmcnt(4)
    v_mfma_f32_16x16x32_bf16 v[160:163], v[128:131], v[48:51], v[160:163]
    ds_read_b64_tr_b16 v[152:153], v6 offset:36032
    v_mfma_f32_16x16x32_bf16 v[164:167], v[128:131], v[52:55], v[164:167]
    ds_read_b64_tr_b16 v[154:155], v6 offset:39616
    s_waitcnt lgkmcnt(4)
    v_mfma_f32_16x16x32_bf16 v[160:163], v[136:139], v[56:59], v[160:163]
    s_waitcnt lgkmcnt(4)
    ds_read_b128 v[16:19], v10 offset:0
    ds_read_b128 v[20:23], v10 offset:32
    ds_read_b128 v[24:27], v12 offset:0
    ds_read_b128 v[28:31], v12 offset:32
    ds_read_b128 v[32:35], v15 offset:0
    ds_read_b128 v[36:39], v15 offset:32
    ds_read_b128 v[40:43], v13 offset:0
    v_mfma_f32_16x16x32_bf16 v[164:167], v[136:139], v[60:63], v[164:167]
    ds_read_b128 v[44:47], v13 offset:32
    s_waitcnt lgkmcnt(0)
    s_barrier
    ds_read_b64_tr_b16 v[128:129], v5 offset:14336
    ds_read_b64_tr_b16 v[130:131], v5 offset:17920
    ds_read_b64_tr_b16 v[132:133], v5 offset:14368
    ds_read_b64_tr_b16 v[134:135], v5 offset:17952
    s_waitcnt lgkmcnt(6)
    v_mfma_f32_16x16x32_bf16 v[160:163], v[144:147], v[64:67], v[160:163]
    ds_read_b64_tr_b16 v[136:137], v5 offset:43008
    ds_read_b64_tr_b16 v[138:139], v5 offset:46592
    v_mfma_f32_16x16x32_bf16 v[164:167], v[144:147], v[68:71], v[164:167]
    ds_read_b64_tr_b16 v[140:141], v5 offset:43040
    ds_read_b64_tr_b16 v[142:143], v5 offset:46624
    s_waitcnt lgkmcnt(8)
    v_mfma_f32_16x16x32_bf16 v[160:163], v[152:155], v[72:75], v[160:163]
    ds_read_b64_tr_b16 v[144:145], v6 offset:14336
    ds_read_b64_tr_b16 v[146:147], v6 offset:17920
    v_mfma_f32_16x16x32_bf16 v[164:167], v[152:155], v[76:79], v[164:167]
    ds_read_b64_tr_b16 v[148:149], v6 offset:14368
    ds_read_b64_tr_b16 v[150:151], v6 offset:17952
    s_waitcnt lgkmcnt(8)
    v_mfma_f32_16x16x32_bf16 v[168:171], v[128:131], v[80:83], v[168:171]
    ds_read_b64_tr_b16 v[152:153], v6 offset:43008
    v_mfma_f32_16x16x32_bf16 v[172:175], v[128:131], v[84:87], v[172:175]
    ds_read_b64_tr_b16 v[154:155], v6 offset:46592
    v_mfma_f32_16x16x32_bf16 v[176:179], v[132:135], v[80:83], v[176:179]
    ds_read_b64_tr_b16 v[156:157], v6 offset:43040
    v_mfma_f32_16x16x32_bf16 v[180:183], v[132:135], v[84:87], v[180:183]
    ds_read_b64_tr_b16 v[158:159], v6 offset:46624
    s_waitcnt lgkmcnt(8)
    v_mfma_f32_16x16x32_bf16 v[168:171], v[136:139], v[88:91], v[168:171]
    ds_read_b64_tr_b16 v[128:129], v5 offset:21504
    v_cndmask_b32 v22, v22, 0, s[82:83]
    v_mfma_f32_16x16x32_bf16 v[172:175], v[136:139], v[92:95], v[172:175]
    ds_read_b64_tr_b16 v[130:131], v5 offset:25088
    v_cndmask_b32 v23, v23, 0, s[82:83]
    v_mfma_f32_16x16x32_bf16 v[176:179], v[140:143], v[88:91], v[176:179]
    ds_read_b64_tr_b16 v[132:133], v5 offset:21536
    v_cndmask_b32 v30, v30, 0, s[82:83]
    v_mfma_f32_16x16x32_bf16 v[180:183], v[140:143], v[92:95], v[180:183]
    ds_read_b64_tr_b16 v[134:135], v5 offset:25120
    v_cndmask_b32 v31, v31, 0, s[82:83]
    s_waitcnt lgkmcnt(8)
    v_mfma_f32_16x16x32_bf16 v[168:171], v[144:147], v[96:99], v[168:171]
    ds_read_b64_tr_b16 v[136:137], v5 offset:50176
    v_cndmask_b32 v38, v38, 0, s[82:83]
    v_mfma_f32_16x16x32_bf16 v[172:175], v[144:147], v[100:103], v[172:175]
    ds_read_b64_tr_b16 v[138:139], v5 offset:53760
    v_cndmask_b32 v39, v39, 0, s[82:83]
    v_mfma_f32_16x16x32_bf16 v[176:179], v[148:151], v[96:99], v[176:179]
    ds_read_b64_tr_b16 v[140:141], v5 offset:50208
    v_cndmask_b32 v46, v46, 0, s[82:83]
    v_mfma_f32_16x16x32_bf16 v[180:183], v[148:151], v[100:103], v[180:183]
    ds_read_b64_tr_b16 v[142:143], v5 offset:53792
    v_cndmask_b32 v47, v47, 0, s[82:83]
    s_waitcnt lgkmcnt(8)
    v_mfma_f32_16x16x32_bf16 v[168:171], v[152:155], v[104:107], v[168:171]
    ds_read_b64_tr_b16 v[144:145], v5 offset:14400
    v_mfma_f32_16x16x32_bf16 v[172:175], v[152:155], v[108:111], v[172:175]
    ds_read_b64_tr_b16 v[146:147], v5 offset:17984
    v_mfma_f32_16x16x32_bf16 v[176:179], v[156:159], v[104:107], v[176:179]
    ds_read_b64_tr_b16 v[148:149], v5 offset:14432
    v_mfma_f32_16x16x32_bf16 v[180:183], v[156:159], v[108:111], v[180:183]
    ds_read_b64_tr_b16 v[150:151], v5 offset:18016
    s_waitcnt lgkmcnt(8)
    v_mfma_f32_16x16x32_bf16 v[168:171], v[128:131], v[112:115], v[168:171]
    ds_read_b64_tr_b16 v[152:153], v5 offset:43072
    v_mfma_f32_16x16x32_bf16 v[172:175], v[128:131], v[116:119], v[172:175]
    ds_read_b64_tr_b16 v[154:155], v5 offset:46656
    v_mfma_f32_16x16x32_bf16 v[176:179], v[132:135], v[112:115], v[176:179]
    ds_read_b64_tr_b16 v[156:157], v5 offset:43104
    v_mfma_f32_16x16x32_bf16 v[180:183], v[132:135], v[116:119], v[180:183]
    ds_read_b64_tr_b16 v[158:159], v5 offset:46688
    s_waitcnt lgkmcnt(8)
    v_mfma_f32_16x16x32_bf16 v[168:171], v[136:139], v[120:123], v[168:171]
    ds_read_b64_tr_b16 v[128:129], v6 offset:14400
    v_mfma_f32_16x16x32_bf16 v[172:175], v[136:139], v[124:127], v[172:175]
    ds_read_b64_tr_b16 v[130:131], v6 offset:17984
    v_mfma_f32_16x16x32_bf16 v[176:179], v[140:143], v[120:123], v[176:179]
    ds_read_b64_tr_b16 v[132:133], v6 offset:14432
    v_mfma_f32_16x16x32_bf16 v[180:183], v[140:143], v[124:127], v[180:183]
    ds_read_b64_tr_b16 v[134:135], v6 offset:18016
    s_waitcnt lgkmcnt(8)
    v_mfma_f32_16x16x32_bf16 v[184:187], v[144:147], v[80:83], v[184:187]
    ds_read_b64_tr_b16 v[136:137], v6 offset:43072
    v_mfma_f32_16x16x32_bf16 v[188:191], v[144:147], v[84:87], v[188:191]
    ds_read_b64_tr_b16 v[138:139], v6 offset:46656
    v_mfma_f32_16x16x32_bf16 v[192:195], v[148:151], v[80:83], v[192:195]
    ds_read_b64_tr_b16 v[140:141], v6 offset:43104
    v_mfma_f32_16x16x32_bf16 v[196:199], v[148:151], v[84:87], v[196:199]
    ds_read_b64_tr_b16 v[142:143], v6 offset:46688
    s_waitcnt lgkmcnt(8)
    v_mfma_f32_16x16x32_bf16 v[184:187], v[152:155], v[88:91], v[184:187]
    ds_read_b64_tr_b16 v[144:145], v5 offset:21568
    v_cvt_pk_bf16_f32 v240, v168, v169
    v_mfma_f32_16x16x32_bf16 v[188:191], v[152:155], v[92:95], v[188:191]
    ds_read_b64_tr_b16 v[146:147], v5 offset:25152
    v_cvt_pk_bf16_f32 v241, v170, v171
    v_mfma_f32_16x16x32_bf16 v[192:195], v[156:159], v[88:91], v[192:195]
    ds_read_b64_tr_b16 v[148:149], v5 offset:21600
    v_cvt_pk_bf16_f32 v242, v176, v177
    v_mfma_f32_16x16x32_bf16 v[196:199], v[156:159], v[92:95], v[196:199]
    ds_read_b64_tr_b16 v[150:151], v5 offset:25184
    v_cvt_pk_bf16_f32 v243, v178, v179
    s_waitcnt lgkmcnt(8)
    v_mfma_f32_16x16x32_bf16 v[184:187], v[128:131], v[96:99], v[184:187]
    ds_read_b64_tr_b16 v[152:153], v5 offset:50240
    v_pk_max_i16 v240, v240, 0
    v_mfma_f32_16x16x32_bf16 v[188:191], v[128:131], v[100:103], v[188:191]
    ds_read_b64_tr_b16 v[154:155], v5 offset:53824
    v_pk_max_i16 v241, v241, 0
    v_mfma_f32_16x16x32_bf16 v[192:195], v[132:135], v[96:99], v[192:195]
    ds_read_b64_tr_b16 v[156:157], v5 offset:50272
    v_pk_max_i16 v242, v242, 0
    v_mfma_f32_16x16x32_bf16 v[196:199], v[132:135], v[100:103], v[196:199]
    ds_read_b64_tr_b16 v[158:159], v5 offset:53856
    v_pk_max_i16 v243, v243, 0
    s_waitcnt lgkmcnt(8)
    v_mfma_f32_16x16x32_bf16 v[184:187], v[136:139], v[104:107], v[184:187]
    ds_read_b64_tr_b16 v[128:129], v5 offset:14464
    buffer_store_dwordx4 v[240:243], v8, s[12:15], s75 offen offset:0 sc1
    v_mfma_f32_16x16x32_bf16 v[188:191], v[136:139], v[108:111], v[188:191]
    ds_read_b64_tr_b16 v[130:131], v5 offset:18048
    v_cvt_pk_bf16_f32 v244, v172, v173
    v_mfma_f32_16x16x32_bf16 v[192:195], v[140:143], v[104:107], v[192:195]
    ds_read_b64_tr_b16 v[132:133], v5 offset:14496
    v_cvt_pk_bf16_f32 v245, v174, v175
    v_mfma_f32_16x16x32_bf16 v[196:199], v[140:143], v[108:111], v[196:199]
    ds_read_b64_tr_b16 v[134:135], v5 offset:18080
    v_cvt_pk_bf16_f32 v246, v180, v181
    s_waitcnt lgkmcnt(8)
    v_mfma_f32_16x16x32_bf16 v[184:187], v[144:147], v[112:115], v[184:187]
    ds_read_b64_tr_b16 v[136:137], v5 offset:43136
    v_cvt_pk_bf16_f32 v247, v182, v183
    v_mfma_f32_16x16x32_bf16 v[188:191], v[144:147], v[116:119], v[188:191]
    ds_read_b64_tr_b16 v[138:139], v5 offset:46720
    v_pk_max_i16 v244, v244, 0
    v_mfma_f32_16x16x32_bf16 v[192:195], v[148:151], v[112:115], v[192:195]
    ds_read_b64_tr_b16 v[140:141], v5 offset:43168
    v_pk_max_i16 v245, v245, 0
    v_mfma_f32_16x16x32_bf16 v[196:199], v[148:151], v[116:119], v[196:199]
    ds_read_b64_tr_b16 v[142:143], v5 offset:46752
    v_pk_max_i16 v246, v246, 0
    s_waitcnt lgkmcnt(8)
    v_mfma_f32_16x16x32_bf16 v[184:187], v[152:155], v[120:123], v[184:187]
    ds_read_b64_tr_b16 v[144:145], v6 offset:14464
    v_pk_max_i16 v247, v247, 0
    v_mfma_f32_16x16x32_bf16 v[188:191], v[152:155], v[124:127], v[188:191]
    ds_read_b64_tr_b16 v[146:147], v6 offset:18048
    buffer_store_dwordx4 v[244:247], v8, s[12:15], s75 offen offset:256 sc1
    v_mfma_f32_16x16x32_bf16 v[192:195], v[156:159], v[120:123], v[192:195]
    ds_read_b64_tr_b16 v[148:149], v6 offset:14496
    v_mfma_f32_16x16x32_bf16 v[196:199], v[156:159], v[124:127], v[196:199]
    ds_read_b64_tr_b16 v[150:151], v6 offset:18080
    s_waitcnt lgkmcnt(8)
    v_mfma_f32_16x16x32_bf16 v[200:203], v[128:131], v[80:83], v[200:203]
    ds_read_b64_tr_b16 v[152:153], v6 offset:43136
    v_mfma_f32_16x16x32_bf16 v[204:207], v[128:131], v[84:87], v[204:207]
    ds_read_b64_tr_b16 v[154:155], v6 offset:46720
    v_mfma_f32_16x16x32_bf16 v[208:211], v[132:135], v[80:83], v[208:211]
    ds_read_b64_tr_b16 v[156:157], v6 offset:43168
    v_mfma_f32_16x16x32_bf16 v[212:215], v[132:135], v[84:87], v[212:215]
    ds_read_b64_tr_b16 v[158:159], v6 offset:46752
    s_waitcnt lgkmcnt(8)
    v_mfma_f32_16x16x32_bf16 v[200:203], v[136:139], v[88:91], v[200:203]
    ds_read_b64_tr_b16 v[128:129], v5 offset:21632
    v_cvt_pk_bf16_f32 v240, v184, v185
    v_mfma_f32_16x16x32_bf16 v[204:207], v[136:139], v[92:95], v[204:207]
    ds_read_b64_tr_b16 v[130:131], v5 offset:25216
    v_cvt_pk_bf16_f32 v241, v186, v187
    v_mfma_f32_16x16x32_bf16 v[208:211], v[140:143], v[88:91], v[208:211]
    ds_read_b64_tr_b16 v[132:133], v5 offset:21664
    v_cvt_pk_bf16_f32 v242, v192, v193
    v_mfma_f32_16x16x32_bf16 v[212:215], v[140:143], v[92:95], v[212:215]
    ds_read_b64_tr_b16 v[134:135], v5 offset:25248
    v_cvt_pk_bf16_f32 v243, v194, v195
    s_waitcnt lgkmcnt(8)
    v_mfma_f32_16x16x32_bf16 v[200:203], v[144:147], v[96:99], v[200:203]
    ds_read_b64_tr_b16 v[136:137], v5 offset:50304
    v_pk_max_i16 v240, v240, 0
    v_mfma_f32_16x16x32_bf16 v[204:207], v[144:147], v[100:103], v[204:207]
    ds_read_b64_tr_b16 v[138:139], v5 offset:53888
    v_pk_max_i16 v241, v241, 0
    v_mfma_f32_16x16x32_bf16 v[208:211], v[148:151], v[96:99], v[208:211]
    ds_read_b64_tr_b16 v[140:141], v5 offset:50336
    v_pk_max_i16 v242, v242, 0
    v_mfma_f32_16x16x32_bf16 v[212:215], v[148:151], v[100:103], v[212:215]
    ds_read_b64_tr_b16 v[142:143], v5 offset:53920
    v_pk_max_i16 v243, v243, 0
    s_waitcnt lgkmcnt(8)
    v_mfma_f32_16x16x32_bf16 v[200:203], v[152:155], v[104:107], v[200:203]
    ds_read_b64_tr_b16 v[144:145], v5 offset:14528
    buffer_store_dwordx4 v[240:243], v8, s[12:15], s75 offen offset:2048 sc1
    v_mfma_f32_16x16x32_bf16 v[204:207], v[152:155], v[108:111], v[204:207]
    ds_read_b64_tr_b16 v[146:147], v5 offset:18112
    v_cvt_pk_bf16_f32 v244, v188, v189
    v_mfma_f32_16x16x32_bf16 v[208:211], v[156:159], v[104:107], v[208:211]
    v_cvt_pk_bf16_f32 v245, v190, v191
    v_mfma_f32_16x16x32_bf16 v[212:215], v[156:159], v[108:111], v[212:215]
    v_cvt_pk_bf16_f32 v246, v196, v197
    s_waitcnt lgkmcnt(6)
    v_mfma_f32_16x16x32_bf16 v[200:203], v[128:131], v[112:115], v[200:203]
    ds_read_b64_tr_b16 v[152:153], v5 offset:43200
    v_cvt_pk_bf16_f32 v247, v198, v199
    v_mfma_f32_16x16x32_bf16 v[204:207], v[128:131], v[116:119], v[204:207]
    ds_read_b64_tr_b16 v[154:155], v5 offset:46784
    v_pk_max_i16 v244, v244, 0
    v_mfma_f32_16x16x32_bf16 v[208:211], v[132:135], v[112:115], v[208:211]
    v_pk_max_i16 v245, v245, 0
    v_mfma_f32_16x16x32_bf16 v[212:215], v[132:135], v[116:119], v[212:215]
    v_pk_max_i16 v246, v246, 0
    s_waitcnt lgkmcnt(4)
    v_mfma_f32_16x16x32_bf16 v[200:203], v[136:139], v[120:123], v[200:203]
    ds_read_b64_tr_b16 v[128:129], v6 offset:14528
    v_pk_max_i16 v247, v247, 0
    v_mfma_f32_16x16x32_bf16 v[204:207], v[136:139], v[124:127], v[204:207]
    ds_read_b64_tr_b16 v[130:131], v6 offset:18112
    buffer_store_dwordx4 v[244:247], v8, s[12:15], s75 offen offset:2304 sc1
    v_mfma_f32_16x16x32_bf16 v[208:211], v[140:143], v[120:123], v[208:211]
    v_mfma_f32_16x16x32_bf16 v[212:215], v[140:143], v[124:127], v[212:215]
    s_waitcnt lgkmcnt(4)
    v_mfma_f32_16x16x32_bf16 v[160:163], v[144:147], v[80:83], v[160:163]
    ds_read_b64_tr_b16 v[136:137], v6 offset:43200
    v_mfma_f32_16x16x32_bf16 v[164:167], v[144:147], v[84:87], v[164:167]
    ds_read_b64_tr_b16 v[138:139], v6 offset:46784
    s_waitcnt lgkmcnt(4)
    v_mfma_f32_16x16x32_bf16 v[160:163], v[152:155], v[88:91], v[160:163]
    ds_read_b64_tr_b16 v[144:145], v5 offset:21696
    v_mfma_f32_16x16x32_bf16 v[164:167], v[152:155], v[92:95], v[164:167]
    ds_read_b64_tr_b16 v[146:147], v5 offset:25280
    s_waitcnt lgkmcnt(4)
    v_mfma_f32_16x16x32_bf16 v[160:163], v[128:131], v[96:99], v[160:163]
    ds_read_b64_tr_b16 v[152:153], v5 offset:50368
    v_cvt_pk_bf16_f32 v240, v200, v201
    v_cvt_pk_bf16_f32 v241, v202, v203
    v_mfma_f32_16x16x32_bf16 v[164:167], v[128:131], v[100:103], v[164:167]
    ds_read_b64_tr_b16 v[154:155], v5 offset:53952
    v_cvt_pk_bf16_f32 v242, v208, v209
    v_cvt_pk_bf16_f32 v243, v210, v211
    s_waitcnt lgkmcnt(4)
    v_mfma_f32_16x16x32_bf16 v[160:163], v[136:139], v[104:107], v[160:163]
    v_pk_max_i16 v240, v240, 0
    v_pk_max_i16 v241, v241, 0
    v_mfma_f32_16x16x32_bf16 v[164:167], v[136:139], v[108:111], v[164:167]
    v_pk_max_i16 v242, v242, 0
    v_pk_max_i16 v243, v243, 0
    s_waitcnt lgkmcnt(2)
    v_mfma_f32_16x16x32_bf16 v[160:163], v[144:147], v[112:115], v[160:163]
    buffer_store_dwordx4 v[240:243], v8, s[12:15], s76 offen offset:0 sc1
    v_cvt_pk_bf16_f32 v244, v204, v205
    v_mfma_f32_16x16x32_bf16 v[164:167], v[144:147], v[116:119], v[164:167]
    v_cvt_pk_bf16_f32 v245, v206, v207
    v_cvt_pk_bf16_f32 v246, v212, v213
    s_waitcnt lgkmcnt(0)
    v_mfma_f32_16x16x32_bf16 v[160:163], v[152:155], v[120:123], v[160:163]
    v_cvt_pk_bf16_f32 v247, v214, v215
    v_pk_max_i16 v244, v244, 0
    v_mfma_f32_16x16x32_bf16 v[164:167], v[152:155], v[124:127], v[164:167]
    v_pk_max_i16 v245, v245, 0
    v_pk_max_i16 v246, v246, 0
    v_pk_max_i16 v247, v247, 0
    buffer_store_dwordx4 v[244:247], v8, s[12:15], s76 offen offset:256 sc1
    v_mfma_f32_32x32x16_bf16 v[80:95], v[232:235], v[232:235], 0
    v_mfma_f32_32x32x16_bf16 v[96:111], v[232:235], v[232:235], 0
    s_nop 3
    v_cvt_pk_bf16_f32 v248, v160, v161
    v_cvt_pk_bf16_f32 v249, v162, v163
    v_pk_max_i16 v248, v248, 0
    v_pk_max_i16 v249, v249, 0
    buffer_store_dwordx2 v[248:249], v9, s[12:15], s76 offen offset:2048 sc1
    v_cvt_pk_bf16_f32 v250, v164, v165
    v_cvt_pk_bf16_f32 v251, v166, v167
    v_pk_max_i16 v250, v250, 0
    v_pk_max_i16 v251, v251, 0
    buffer_store_dwordx2 v[250:251], v9, s[12:15], s76 offen offset:2304 sc1
    v_mfma_f32_32x32x16_bf16 v[48:63], v[232:235], v[232:235], 0
    v_mfma_f32_32x32x16_bf16 v[64:79], v[232:235], v[232:235], 0
    s_barrier
    s_setprio 1
    s_mov_b32 s33, s77
    buffer_load_dwordx4 v[176:179], v1, s[64:67], s33 offen offset:0 sc1
    buffer_load_dwordx4 v[180:183], v1, s[64:67], s33 offen offset:1024 sc1
    buffer_load_dwordx4 v[184:187], v1, s[64:67], s33 offen offset:2048 sc1
    buffer_load_dwordx4 v[188:191], v1, s[64:67], s33 offen offset:3072 sc1
    s_add_u32 s33, s33, 4096
    buffer_load_dwordx4 v[192:195], v1, s[64:67], s33 offen offset:0 sc1
    buffer_load_dwordx4 v[196:199], v1, s[64:67], s33 offen offset:1024 sc1
    buffer_load_dwordx4 v[200:203], v1, s[64:67], s33 offen offset:2048 sc1
    buffer_load_dwordx4 v[204:207], v1, s[64:67], s33 offen offset:3072 sc1
    s_add_u32 s33, s33, 4096
    buffer_load_dwordx4 v[208:211], v1, s[64:67], s33 offen offset:0 sc1
    buffer_load_dwordx4 v[212:215], v1, s[64:67], s33 offen offset:1024 sc1
    buffer_load_dwordx4 v[216:219], v1, s[64:67], s33 offen offset:2048 sc1
    buffer_load_dwordx4 v[220:223], v1, s[64:67], s33 offen offset:3072 sc1
    s_add_u32 s33, s33, 4096
    buffer_load_dword v253, v11, s[12:15], s7 offen sc1
    s_waitcnt vmcnt(13)
    v_mov_b32 v254, s73
    s_mov_b64 exec, 1
    buffer_store_dword v254, off, s[12:15], s81 sc1
    s_mov_b64 exec, -1
    s_waitcnt vmcnt(12)
    v_mfma_f32_32x32x16_bf16 v[112:127], v[176:179], v[16:19], 0
    v_mfma_f32_32x32x16_bf16 v[112:127], v[180:183], v[20:23], v[112:127]
    v_mfma_f32_32x32x16_bf16 v[128:143], v[176:179], v[24:27], 0
    v_mfma_f32_32x32x16_bf16 v[128:143], v[180:183], v[28:31], v[128:143]
    v_mfma_f32_32x32x16_bf16 v[144:159], v[176:179], v[32:35], 0
    v_mfma_f32_32x32x16_bf16 v[144:159], v[180:183], v[36:39], v[144:159]
    s_nop 7
    v_mfma_f32_32x32x16_bf16 v[160:175], v[176:179], v[40:43], 0
    v_max_f32 v240, v112, v113
    v_max3_f32 v240, v240, v114, v115
    v_max3_f32 v240, v240, v116, v117
    v_max3_f32 v240, v240, v118, v119
    v_max3_f32 v240, v240, v120, v121
    v_max3_f32 v240, v240, v122, v123
    v_max3_f32 v240, v240, v124, v125
    v_max3_f32 v240, v240, v126, v127
    v_mfma_f32_32x32x16_bf16 v[160:175], v[180:183], v[44:47], v[160:175]
    v_max_f32 v241, v128, v129
    v_max3_f32 v241, v241, v130, v131
    v_max3_f32 v241, v241, v132, v133
    v_max3_f32 v241, v241, v134, v135
    v_max3_f32 v241, v241, v136, v137
    v_max3_f32 v241, v241, v138, v139
    v_max3_f32 v241, v241, v140, v141
    v_max3_f32 v241, v241, v142, v143
    v_mov_b32 v244, v240
    s_nop 1
    v_permlane32_swap_b32 v240, v244
    v_max_f32 v240, v240, v244
    v_and_b32 v240, 0xffff0000, v240
    v_lshrrev_b32 v244, 16, v240
    v_xor_b32 v244, 0x8000, v244
    v_cndmask_b32 v22, v22, v244, s[82:83]
    v_max_f32 v242, v144, v145
    v_max3_f32 v242, v242, v146, v147
    v_max3_f32 v242, v242, v148, v149
    v_max3_f32 v242, v242, v150, v151
    v_max3_f32 v242, v242, v152, v153
    v_max3_f32 v242, v242, v154, v155
    v_max3_f32 v242, v242, v156, v157
    v_max3_f32 v242, v242, v158, v159
    v_mfma_f32_32x32x16_bf16 v[112:127], v[176:179], v[16:19], 0
    v_mov_b32 v245, v241
    s_nop 1
    v_permlane32_swap_b32 v241, v245
    v_max_f32 v241, v241, v245
    v_and_b32 v241, 0xffff0000, v241
    v_lshrrev_b32 v245, 16, v241
    v_xor_b32 v245, 0x8000, v245
    v_cndmask_b32 v30, v30, v245, s[82:83]
    v_mfma_f32_32x32x16_bf16 v[112:127], v[180:183], v[20:23], v[112:127]
    v_max_f32 v243, v160, v161
    v_max3_f32 v243, v243, v162, v163
    v_max3_f32 v243, v243, v164, v165
    v_max3_f32 v243, v243, v166, v167
    v_max3_f32 v243, v243, v168, v169
    v_max3_f32 v243, v243, v170, v171
    v_max3_f32 v243, v243, v172, v173
    v_max3_f32 v243, v243, v174, v175
    v_mov_b32 v246, v242
    s_nop 1
    v_permlane32_swap_b32 v242, v246
    v_max_f32 v242, v242, v246
    v_and_b32 v242, 0xffff0000, v242
    v_lshrrev_b32 v246, 16, v242
    v_xor_b32 v246, 0x8000, v246
    v_cndmask_b32 v38, v38, v246, s[82:83]
    v_mov_b32 v247, v243
    s_nop 1
    v_permlane32_swap_b32 v243, v247
    v_max_f32 v243, v243, v247
    v_and_b32 v243, 0xffff0000, v243
    v_lshrrev_b32 v247, 16, v243
    v_xor_b32 v247, 0x8000, v247
    v_cndmask_b32 v46, v46, v247, s[82:83]
L_go:
    ds_write_b32 v2, v240 offset:12288
    ds_write_b32 v3, v241 offset:8196
    ds_write_b32 v4, v242 offset:4104
    s_mov_b32 s79, 4
    s_branch L_att0
    .p2align 3
L_att:
    v_mfma_f32_32x32x16_bf16 v[160:175], v[224:227], v[40:43], 0
    v_exp_f32 v144, v144
    v_exp_f32 v145, v145
    v_exp_f32 v146, v146
    v_mfma_f32_32x32x16_bf16 v[160:175], v[228:231], v[44:47], v[160:175]
    v_exp_f32 v147, v147
    v_exp_f32 v148, v148
    v_exp_f32 v149, v149
    v_smfmac_f32_32x32x32_bf16 v[64:79], v[232:235], v[128:135], v252
    v_exp_f32 v150, v150
    v_exp_f32 v151, v151
    v_smfmac_f32_32x32x32_bf16 v[64:79], v[236:239], v[136:143], v252
    v_exp_f32 v152, v152
    v_exp_f32 v153, v153
    v_exp_f32 v154, v154
    v_exp_f32 v155, v155
    v_exp_f32 v156, v156
    v_exp_f32 v157, v157
    v_exp_f32 v158, v158
    v_exp_f32 v159, v159
    s_waitcnt vmcnt(10)
    v_mfma_f32_32x32x16_bf16 v[112:127], v[176:179], v[16:19], 0
    v_exp_f32 v160, v160
    v_exp_f32 v161, v161
    v_exp_f32 v162, v162
    v_mfma_f32_32x32x16_bf16 v[112:127], v[180:183], v[20:23], v[112:127]
    v_exp_f32 v163, v163
    v_exp_f32 v164, v164
    v_exp_f32 v165, v165
    v_smfmac_f32_32x32x32_bf16 v[80:95], v[232:235], v[144:151], v252
    v_exp_f32 v166, v166
    v_exp_f32 v167, v167
    v_smfmac_f32_32x32x32_bf16 v[80:95], v[236:239], v[152:159], v252
    v_exp_f32 v168, v168
    v_exp_f32 v169, v169
    v_exp_f32 v170, v170
    v_exp_f32 v171, v171
    v_exp_f32 v172, v172
    v_exp_f32 v173, v173
    v_exp_f32 v174, v174
    v_exp_f32 v175, v175
L_att0:
    v_mfma_f32_32x32x16_bf16 v[128:143], v[176:179], v[24:27], 0
    v_exp_f32 v112, v112
    v_exp_f32 v113, v113
    v_exp_f32 v114, v114
    v_mfma_f32_32x32x16_bf16 v[128:143], v[180:183], v[28:31], v[128:143]
    v_exp_f32 v115, v115
    v_exp_f32 v116, v116
    v_exp_f32 v117, v117
    v_smfmac_f32_32x32x32_bf16 v[96:111], v[232:235], v[160:167], v252
    v_exp_f32 v118, v118
    v_exp_f32 v119, v119
    v_smfmac_f32_32x32x32_bf16 v[96:111], v[236:239], v[168:175], v252
    v_exp_f32 v120, v120
    v_exp_f32 v121, v121
    v_exp_f32 v122, v122
    v_exp_f32 v123, v123
    v_exp_f32 v124, v124
    v_exp_f32 v125, v125
    v_exp_f32 v126, v126
    v_exp_f32 v127, v127
    v_mfma_f32_32x32x16_bf16 v[144:159], v[176:179], v[32:35], 0
    buffer_load_dwordx4 v[224:227], v1, s[64:67], s33 offen offset:0 sc1
    v_exp_f32 v128, v128
    v_exp_f32 v129, v129
    v_exp_f32 v130, v130
    v_mfma_f32_32x32x16_bf16 v[144:159], v[180:183], v[36:39], v[144:159]
    buffer_load_dwordx4 v[228:231], v1, s[64:67], s33 offen offset:1024 sc1
    v_exp_f32 v131, v131
    v_exp_f32 v132, v132
    v_exp_f32 v133, v133
    s_waitcnt vmcnt(10)
    v_smfmac_f32_32x32x32_bf16 v[48:63], v[184:187], v[112:119], v252
    buffer_load_dwordx4 v[232:235], v1, s[64:67], s33 offen offset:2048 sc1
    v_exp_f32 v134, v134
    v_exp_f32 v135, v135
    v_smfmac_f32_32x32x32_bf16 v[48:63], v[188:191], v[120:127], v252
    buffer_load_dwordx4 v[236:239], v1, s[64:67], s33 offen offset:3072 sc1
    v_exp_f32 v136, v136
    v_exp_f32 v137, v137
    v_exp_f32 v138, v138
    v_exp_f32 v139, v139
    v_exp_f32 v140, v140
    v_exp_f32 v141, v141
    v_exp_f32 v142, v142
    v_exp_f32 v143, v143
    s_add_u32 s33, s33, 4096
    v_mfma_f32_32x32x16_bf16 v[160:175], v[176:179], v[40:43], 0
    v_exp_f32 v144, v144
    v_exp_f32 v145, v145
    v_exp_f32 v146, v146
    v_mfma_f32_32x32x16_bf16 v[160:175], v[180:183], v[44:47], v[160:175]
    v_exp_f32 v147, v147
    v_exp_f32 v148, v148
    v_exp_f32 v149, v149
    v_smfmac_f32_32x32x32_bf16 v[64:79], v[184:187], v[128:135], v252
    v_exp_f32 v150, v150
    v_exp_f32 v151, v151
    v_smfmac_f32_32x32x32_bf16 v[64:79], v[188:191], v[136:143], v252
    v_exp_f32 v152, v152
    v_exp_f32 v153, v153
    v_exp_f32 v154, v154
    v_exp_f32 v155, v155
    v_exp_f32 v156, v156
    v_exp_f32 v157, v157
    v_exp_f32 v158, v158
    v_exp_f32 v159, v159
    s_waitcnt vmcnt(10)
    v_mfma_f32_32x32x16_bf16 v[112:127], v[192:195], v[16:19], 0
    v_exp_f32 v160, v160
    v_exp_f32 v161, v161
    v_exp_f32 v162, v162
    v_mfma_f32_32x32x16_bf16 v[112:127], v[196:199], v[20:23], v[112:127]
    v_exp_f32 v163, v163
    v_exp_f32 v164, v164
    v_exp_f32 v165, v165
    v_smfmac_f32_32x32x32_bf16 v[80:95], v[184:187], v[144:151], v252
    v_exp_f32 v166, v166
    v_exp_f32 v167, v167
    v_smfmac_f32_32x32x32_bf16 v[80:95], v[188:191], v[152:159], v252
    v_exp_f32 v168, v168
    v_exp_f32 v169, v169
    v_exp_f32 v170, v170
    v_exp_f32 v171, v171
    v_exp_f32 v172, v172
    v_exp_f32 v173, v173
    v_exp_f32 v174, v174
    v_exp_f32 v175, v175
    v_mfma_f32_32x32x16_bf16 v[128:143], v[192:195], v[24:27], 0
    v_exp_f32 v112, v112
    v_exp_f32 v113, v113
    v_exp_f32 v114, v114
    v_mfma_f32_32x32x16_bf16 v[128:143], v[196:199], v[28:31], v[128:143]
    v_exp_f32 v115, v115
    v_exp_f32 v116, v116
    v_exp_f32 v117, v117
    v_smfmac_f32_32x32x32_bf16 v[96:111], v[184:187], v[160:167], v252
    v_exp_f32 v118, v118
    v_exp_f32 v119, v119
    v_smfmac_f32_32x32x32_bf16 v[96:111], v[188:191], v[168:175], v252
    v_exp_f32 v120, v120
    v_exp_f32 v121, v121
    v_exp_f32 v122, v122
    v_exp_f32 v123, v123
    v_exp_f32 v124, v124
    v_exp_f32 v125, v125
    v_exp_f32 v126, v126
    v_exp_f32 v127, v127
    v_mfma_f32_32x32x16_bf16 v[144:159], v[192:195], v[32:35], 0
    buffer_load_dwordx4 v[176:179], v1, s[64:67], s33 offen offset:0 sc1
    v_exp_f32 v128, v128
    v_exp_f32 v129, v129
    v_exp_f32 v130, v130
    v_mfma_f32_32x32x16_bf16 v[144:159], v[196:199], v[36:39], v[144:159]
    buffer_load_dwordx4 v[180:183], v1, s[64:67], s33 offen offset:1024 sc1
    v_exp_f32 v131, v131
    v_exp_f32 v132, v132
    v_exp_f32 v133, v133
    s_waitcnt vmcnt(10)
    v_smfmac_f32_32x32x32_bf16 v[48:63], v[200:203], v[112:119], v252
    buffer_load_dwordx4 v[184:187], v1, s[64:67], s33 offen offset:2048 sc1
    v_exp_f32 v134, v134
    v_exp_f32 v135, v135
    v_smfmac_f32_32x32x32_bf16 v[48:63], v[204:207], v[120:127], v252
    buffer_load_dwordx4 v[188:191], v1, s[64:67], s33 offen offset:3072 sc1
    v_exp_f32 v136, v136
    v_exp_f32 v137, v137
    v_exp_f32 v138, v138
    v_exp_f32 v139, v139
    v_exp_f32 v140, v140
    v_exp_f32 v141, v141
    v_exp_f32 v142, v142
    v_exp_f32 v143, v143
    s_add_u32 s33, s33, 4096
    v_mfma_f32_32x32x16_bf16 v[160:175], v[192:195], v[40:43], 0
    v_exp_f32 v144, v144
    v_exp_f32 v145, v145
    v_exp_f32 v146, v146
    v_mfma_f32_32x32x16_bf16 v[160:175], v[196:199], v[44:47], v[160:175]
    v_exp_f32 v147, v147
    v_exp_f32 v148, v148
    v_exp_f32 v149, v149
    v_smfmac_f32_32x32x32_bf16 v[64:79], v[200:203], v[128:135], v252
    v_exp_f32 v150, v150
    v_exp_f32 v151, v151
    v_smfmac_f32_32x32x32_bf16 v[64:79], v[204:207], v[136:143], v252
    v_exp_f32 v152, v152
    v_exp_f32 v153, v153
    v_exp_f32 v154, v154
    v_exp_f32 v155, v155
    v_exp_f32 v156, v156
    v_exp_f32 v157, v157
    v_exp_f32 v158, v158
    v_exp_f32 v159, v159
    s_waitcnt vmcnt(10)
    v_mfma_f32_32x32x16_bf16 v[112:127], v[208:211], v[16:19], 0
    v_exp_f32 v160, v160
    v_exp_f32 v161, v161
    v_exp_f32 v162, v162
    v_mfma_f32_32x32x16_bf16 v[112:127], v[212:215], v[20:23], v[112:127]
    v_exp_f32 v163, v163
    v_exp_f32 v164, v164
    v_exp_f32 v165, v165
    v_smfmac_f32_32x32x32_bf16 v[80:95], v[200:203], v[144:151], v252
    v_exp_f32 v166, v166
    v_exp_f32 v167, v167
    v_smfmac_f32_32x32x32_bf16 v[80:95], v[204:207], v[152:159], v252
    v_exp_f32 v168, v168
    v_exp_f32 v169, v169
    v_exp_f32 v170, v170
    v_exp_f32 v171, v171
    v_exp_f32 v172, v172
    v_exp_f32 v173, v173
    v_exp_f32 v174, v174
    v_exp_f32 v175, v175
    v_mfma_f32_32x32x16_bf16 v[128:143], v[208:211], v[24:27], 0
    v_exp_f32 v112, v112
    v_exp_f32 v113, v113
    v_exp_f32 v114, v114
    v_mfma_f32_32x32x16_bf16 v[128:143], v[212:215], v[28:31], v[128:143]
    v_exp_f32 v115, v115
    v_exp_f32 v116, v116
    v_exp_f32 v117, v117
    v_smfmac_f32_32x32x32_bf16 v[96:111], v[200:203], v[160:167], v252
    v_exp_f32 v118, v118
    v_exp_f32 v119, v119
    v_smfmac_f32_32x32x32_bf16 v[96:111], v[204:207], v[168:175], v252
    v_exp_f32 v120, v120
    v_exp_f32 v121, v121
    v_exp_f32 v122, v122
    v_exp_f32 v123, v123
    v_exp_f32 v124, v124
    v_exp_f32 v125, v125
    v_exp_f32 v126, v126
    v_exp_f32 v127, v127
    v_mfma_f32_32x32x16_bf16 v[144:159], v[208:211], v[32:35], 0
    buffer_load_dwordx4 v[192:195], v1, s[64:67], s33 offen offset:0 sc1
    v_exp_f32 v128, v128
    v_exp_f32 v129, v129
    v_exp_f32 v130, v130
    v_mfma_f32_32x32x16_bf16 v[144:159], v[212:215], v[36:39], v[144:159]
    buffer_load_dwordx4 v[196:199], v1, s[64:67], s33 offen offset:1024 sc1
    v_exp_f32 v131, v131
    v_exp_f32 v132, v132
    v_exp_f32 v133, v133
    s_waitcnt vmcnt(10)
    v_smfmac_f32_32x32x32_bf16 v[48:63], v[216:219], v[112:119], v252
    buffer_load_dwordx4 v[200:203], v1, s[64:67], s33 offen offset:2048 sc1
    v_exp_f32 v134, v134
    v_exp_f32 v135, v135
    v_smfmac_f32_32x32x32_bf16 v[48:63], v[220:223], v[120:127], v252
    buffer_load_dwordx4 v[204:207], v1, s[64:67], s33 offen offset:3072 sc1
    v_exp_f32 v136, v136
    v_exp_f32 v137, v137
    v_exp_f32 v138, v138
    v_exp_f32 v139, v139
    v_exp_f32 v140, v140
    v_exp_f32 v141, v141
    v_exp_f32 v142, v142
    v_exp_f32 v143, v143
    s_add_u32 s33, s33, 4096
    v_mfma_f32_32x32x16_bf16 v[160:175], v[208:211], v[40:43], 0
    v_exp_f32 v144, v144
    v_exp_f32 v145, v145
    v_exp_f32 v146, v146
    v_mfma_f32_32x32x16_bf16 v[160:175], v[212:215], v[44:47], v[160:175]
    v_exp_f32 v147, v147
    v_exp_f32 v148, v148
    v_exp_f32 v149, v149
    v_smfmac_f32_32x32x32_bf16 v[64:79], v[216:219], v[128:135], v252
    v_exp_f32 v150, v150
    v_exp_f32 v151, v151
    v_smfmac_f32_32x32x32_bf16 v[64:79], v[220:223], v[136:143], v252
    v_exp_f32 v152, v152
    v_exp_f32 v153, v153
    v_exp_f32 v154, v154
    v_exp_f32 v155, v155
    v_exp_f32 v156, v156
    v_exp_f32 v157, v157
    v_exp_f32 v158, v158
    v_exp_f32 v159, v159
    s_waitcnt vmcnt(10)
    v_mfma_f32_32x32x16_bf16 v[112:127], v[224:227], v[16:19], 0
    v_exp_f32 v160, v160
    v_exp_f32 v161, v161
    v_exp_f32 v162, v162
    v_mfma_f32_32x32x16_bf16 v[112:127], v[228:231], v[20:23], v[112:127]
    v_exp_f32 v163, v163
    v_exp_f32 v164, v164
    v_exp_f32 v165, v165
    v_smfmac_f32_32x32x32_bf16 v[80:95], v[216:219], v[144:151], v252
    v_exp_f32 v166, v166
    v_exp_f32 v167, v167
    v_smfmac_f32_32x32x32_bf16 v[80:95], v[220:223], v[152:159], v252
    v_exp_f32 v168, v168
    v_exp_f32 v169, v169
    v_exp_f32 v170, v170
    v_exp_f32 v171, v171
    v_exp_f32 v172, v172
    v_exp_f32 v173, v173
    v_exp_f32 v174, v174
    v_exp_f32 v175, v175
    v_mfma_f32_32x32x16_bf16 v[128:143], v[224:227], v[24:27], 0
    v_exp_f32 v112, v112
    v_exp_f32 v113, v113
    v_exp_f32 v114, v114
    v_mfma_f32_32x32x16_bf16 v[128:143], v[228:231], v[28:31], v[128:143]
    v_exp_f32 v115, v115
    v_exp_f32 v116, v116
    v_exp_f32 v117, v117
    v_smfmac_f32_32x32x32_bf16 v[96:111], v[216:219], v[160:167], v252
    v_exp_f32 v118, v118
    v_exp_f32 v119, v119
    v_smfmac_f32_32x32x32_bf16 v[96:111], v[220:223], v[168:175], v252
    v_exp_f32 v120, v120
    v_exp_f32 v121, v121
    v_exp_f32 v122, v122
    v_exp_f32 v123, v123
    v_exp_f32 v124, v124
    v_exp_f32 v125, v125
    v_exp_f32 v126, v126
    v_exp_f32 v127, v127
    s_sub_u32 s79, s79, 1
    v_mfma_f32_32x32x16_bf16 v[144:159], v[224:227], v[32:35], 0
    buffer_load_dwordx4 v[208:211], v1, s[64:67], s33 offen offset:0 sc1
    v_exp_f32 v128, v128
    v_exp_f32 v129, v129
    v_exp_f32 v130, v130
    v_mfma_f32_32x32x16_bf16 v[144:159], v[228:231], v[36:39], v[144:159]
    buffer_load_dwordx4 v[212:215], v1, s[64:67], s33 offen offset:1024 sc1
    v_exp_f32 v131, v131
    v_exp_f32 v132, v132
    v_exp_f32 v133, v133
    s_waitcnt vmcnt(10)
    v_smfmac_f32_32x32x32_bf16 v[48:63], v[232:235], v[112:119], v252
    buffer_load_dwordx4 v[216:219], v1, s[64:67], s33 offen offset:2048 sc1
    v_exp_f32 v134, v134
    v_exp_f32 v135, v135
    v_smfmac_f32_32x32x32_bf16 v[48:63], v[236:239], v[120:127], v252
    buffer_load_dwordx4 v[220:223], v1, s[64:67], s33 offen offset:3072 sc1
    v_exp_f32 v136, v136
    v_exp_f32 v137, v137
    v_exp_f32 v138, v138
    v_exp_f32 v139, v139
    v_exp_f32 v140, v140
    v_exp_f32 v141, v141
    v_exp_f32 v142, v142
    v_exp_f32 v143, v143
    s_add_u32 s33, s33, 4096
    s_cmp_lg_u32 s79, 0
    s_cbranch_scc1 L_att
    v_mfma_f32_32x32x16_bf16 v[160:175], v[224:227], v[40:43], 0
    v_exp_f32 v144, v144
    v_exp_f32 v145, v145
    v_exp_f32 v146, v146
    v_exp_f32 v147, v147
    v_mfma_f32_32x32x16_bf16 v[160:175], v[228:231], v[44:47], v[160:175]
    v_exp_f32 v148, v148
    v_exp_f32 v149, v149
    v_exp_f32 v150, v150
    v_exp_f32 v151, v151
    v_smfmac_f32_32x32x32_bf16 v[64:79], v[232:235], v[128:135], v252
    v_exp_f32 v152, v152
    v_exp_f32 v153, v153
    v_exp_f32 v154, v154
    v_exp_f32 v155, v155
    ds_write_b128 v2, v[48:51] offset:0
    ds_write_b128 v2, v[52:55] offset:1024
    v_smfmac_f32_32x32x32_bf16 v[64:79], v[236:239], v[136:143], v252
    ds_write_b128 v2, v[56:59] offset:2048
    ds_write_b128 v2, v[60:63] offset:3072
    v_exp_f32 v156, v156
    v_exp_f32 v157, v157
    v_exp_f32 v158, v158
    v_exp_f32 v159, v159
    v_exp_f32 v160, v160
    v_exp_f32 v161, v161
    v_exp_f32 v162, v162
    v_exp_f32 v163, v163
    v_exp_f32 v164, v164
    v_exp_f32 v165, v165
    v_exp_f32 v166, v166
    v_exp_f32 v167, v167
    v_smfmac_f32_32x32x32_bf16 v[80:95], v[232:235], v[144:151], v252
    v_exp_f32 v168, v168
    v_exp_f32 v169, v169
    v_exp_f32 v170, v170
    v_exp_f32 v171, v171
    ds_write_b128 v3, v[64:67] offset:0
    ds_write_b128 v3, v[68:71] offset:1024
    v_smfmac_f32_32x32x32_bf16 v[80:95], v[236:239], v[152:159], v252
    ds_write_b128 v3, v[72:75] offset:2048
    ds_write_b128 v3, v[76:79] offset:3072
    v_exp_f32 v172, v172
    v_exp_f32 v173, v173
    v_exp_f32 v174, v174
    v_exp_f32 v175, v175
    s_nop 0
    v_smfmac_f32_32x32x32_bf16 v[96:111], v[232:235], v[160:167], v252
    v_smfmac_f32_32x32x32_bf16 v[96:111], v[236:239], v[168:175], v252
    v_add_f32 v8, v55, v71
    v_min_f32 v9, v55, v71
    s_nop 7
    ds_write_b128 v4, v[80:83] offset:0
    ds_write_b128 v4, v[84:87] offset:1024
    ds_write_b128 v4, v[88:91] offset:2048
    ds_write_b128 v4, v[92:95] offset:3072
    s_nop 7
    v_add_f32 v10, v87, v103
    v_add_f32 v8, v8, v10
    v_min3_f32 v9, v9, v87, v103
    v_cmp_gt_f32 vcc, 0x2b800000, v9
    s_nop 0
    s_mov_b64 s[4:5], vcc
    v_cmp_ngt_f32 vcc, 0x53800000, v8
    s_nop 0
    s_or_b64 vcc, vcc, s[4:5]
    s_cmp_lg_u32 s80, 0
    s_cbranch_scc1 L_merge
    s_cbranch_vccnz L_fb
L_merge:
    s_waitcnt lgkmcnt(0)
    s_barrier
    ds_read_b96 v[240:242], v14 offset:12288
    ds_read_b128 v[112:115], v14 offset:0
    ds_read_b128 v[116:119], v14 offset:1024
    ds_read_b128 v[120:123], v14 offset:2048
    ds_read_b128 v[124:127], v14 offset:3072
    ds_read_b128 v[128:131], v14 offset:4096
    ds_read_b128 v[132:135], v14 offset:5120
    ds_read_b128 v[136:139], v14 offset:6144
    ds_read_b128 v[140:143], v14 offset:7168
    ds_read_b128 v[144:147], v14 offset:8192
    ds_read_b128 v[148:151], v14 offset:9216
    ds_read_b128 v[152:155], v14 offset:10240
    ds_read_b128 v[156:159], v14 offset:11264
    s_waitcnt lgkmcnt(12)
    v_max3_f32 v3, v240, v241, v242
    v_max_f32 v3, v3, v243
    v_sub_f32 v243, v243, v3
    v_sub_f32 v240, v240, v3
    v_sub_f32 v241, v241, v3
    v_sub_f32 v242, v242, v3
    v_exp_f32 v243, v243
    v_exp_f32 v240, v240
    v_exp_f32 v241, v241
    v_exp_f32 v242, v242
    v_mul_f32 v96, v243, v96
    v_mul_f32 v97, v243, v97
    v_mul_f32 v98, v243, v98
    v_mul_f32 v99, v243, v99
    v_mul_f32 v100, v243, v100
    v_mul_f32 v101, v243, v101
    v_mul_f32 v102, v243, v102
    v_mul_f32 v103, v243, v103
    v_mul_f32 v104, v243, v104
    v_mul_f32 v105, v243, v105
    v_mul_f32 v106, v243, v106
    v_mul_f32 v107, v243, v107
    v_mul_f32 v108, v243, v108
    v_mul_f32 v109, v243, v109
    v_mul_f32 v110, v243, v110
    s_waitcnt lgkmcnt(8)
    v_fmac_f32 v96, v240, v112
    v_fmac_f32 v97, v240, v113
    v_fmac_f32 v98, v240, v114
    v_fmac_f32 v99, v240, v115
    v_fmac_f32 v100, v240, v116
    v_fmac_f32 v101, v240, v117
    v_fmac_f32 v102, v240, v118
    v_fmac_f32 v103, v240, v119
    v_fmac_f32 v104, v240, v120
    v_fmac_f32 v105, v240, v121
    v_fmac_f32 v106, v240, v122
    v_fmac_f32 v107, v240, v123
    v_fmac_f32 v108, v240, v124
    v_fmac_f32 v109, v240, v125
    v_fmac_f32 v110, v240, v126
    s_waitcnt lgkmcnt(4)
    v_fmac_f32 v96, v241, v128
    v_fmac_f32 v97, v241, v129
    v_fmac_f32 v98, v241, v130
    v_fmac_f32 v99, v241, v131
    v_fmac_f32 v100, v241, v132
    v_fmac_f32 v101, v241, v133
    v_fmac_f32 v102, v241, v134
    v_fmac_f32 v103, v241, v135
    v_fmac_f32 v104, v241, v136
    v_fmac_f32 v105, v241, v137
    v_fmac_f32 v106, v241, v138
    v_fmac_f32 v107, v241, v139
    v_fmac_f32 v108, v241, v140
    v_fmac_f32 v109, v241, v141
    v_fmac_f32 v110, v241, v142
    s_waitcnt lgkmcnt(0)
    v_fmac_f32 v103, v242, v151
    v_fmac_f32 v96, v242, v144
    v_rcp_f32 v3, v103
    v_fmac_f32 v97, v242, v145
    v_fmac_f32 v98, v242, v146
    v_fmac_f32 v99, v242, v147
    v_fmac_f32 v100, v242, v148
    v_fmac_f32 v101, v242, v149
    v_fmac_f32 v102, v242, v150
    v_fmac_f32 v104, v242, v152
    v_fmac_f32 v105, v242, v153
    v_fmac_f32 v106, v242, v154
    v_fmac_f32 v107, v242, v155
    v_fmac_f32 v108, v242, v156
    v_fmac_f32 v109, v242, v157
    v_fmac_f32 v110, v242, v158
    v_mul_f32 v3, v3, v253
    v_mul_f32 v96, v3, v96
    v_mul_f32 v97, v3, v97
    v_mul_f32 v98, v3, v98
    v_mul_f32 v99, v3, v99
    v_mul_f32 v100, v3, v100
    v_mul_f32 v101, v3, v101
    v_mul_f32 v102, v3, v102
    v_cvt_pk_bf16_f32 v8, v96, v97
    v_cvt_pk_bf16_f32 v9, v98, v99
    v_cvt_pk_bf16_f32 v10, v100, v101
    v_cvt_pk_bf16_f32 v11, v102, 0
    v_or_b32 v11, s3, v11
    buffer_store_dwordx4 v[8:11], v1, s[12:15], s6 offen offset:0 sc1
    v_mul_f32 v104, v3, v104
    v_mul_f32 v105, v3, v105
    v_mul_f32 v106, v3, v106
    v_mul_f32 v107, v3, v107
    v_mul_f32 v108, v3, v108
    v_mul_f32 v109, v3, v109
    v_mul_f32 v110, v3, v110
    v_cvt_pk_bf16_f32 v12, v104, v105
    v_cvt_pk_bf16_f32 v13, v106, v107
    v_cvt_pk_bf16_f32 v14, v108, v109
    v_cvt_pk_bf16_f32 v15, v110, 0
    v_or_b32 v15, s3, v15
    buffer_store_dwordx4 v[12:15], v1, s[12:15], s6 offen offset:1024 sc1
    s_endpgm
L_fb:
    s_mov_b32 s80, 1
    s_waitcnt vmcnt(0) lgkmcnt(0)
    v_cndmask_b32 v22, v22, 0, s[82:83]
    v_cndmask_b32 v23, v23, 0, s[82:83]
    v_cndmask_b32 v30, v30, 0, s[82:83]
    v_cndmask_b32 v31, v31, 0, s[82:83]
    v_cndmask_b32 v38, v38, 0, s[82:83]
    v_cndmask_b32 v39, v39, 0, s[82:83]
    v_cndmask_b32 v46, v46, 0, s[82:83]
    v_cndmask_b32 v47, v47, 0, s[82:83]
    v_mov_b32 v240, 0xff800000
    v_mov_b32 v241, 0xff800000
    v_mov_b32 v242, 0xff800000
    v_mov_b32 v243, 0xff800000
    s_mov_b32 s33, s77
    s_mov_b32 s79, 16
L_fbl:
    buffer_load_dwordx4 v[224:227], v1, s[64:67], s33 offen offset:0 sc1
    buffer_load_dwordx4 v[228:231], v1, s[64:67], s33 offen offset:1024 sc1
    s_add_u32 s33, s33, 4096
    s_waitcnt vmcnt(0)
    v_mfma_f32_32x32x16_bf16 v[112:127], v[224:227], v[16:19], 0
    v_mfma_f32_32x32x16_bf16 v[112:127], v[228:231], v[20:23], v[112:127]
    v_mfma_f32_32x32x16_bf16 v[128:143], v[224:227], v[24:27], 0
    v_mfma_f32_32x32x16_bf16 v[128:143], v[228:231], v[28:31], v[128:143]
    v_mfma_f32_32x32x16_bf16 v[144:159], v[224:227], v[32:35], 0
    v_mfma_f32_32x32x16_bf16 v[144:159], v[228:231], v[36:39], v[144:159]
    v_mfma_f32_32x32x16_bf16 v[160:175], v[224:227], v[40:43], 0
    v_mfma_f32_32x32x16_bf16 v[160:175], v[228:231], v[44:47], v[160:175]
    s_nop 5
    v_max3_f32 v240, v240, v112, v113
    v_max3_f32 v240, v240, v114, v115
    v_max3_f32 v240, v240, v116, v117
    v_max3_f32 v240, v240, v118, v119
    v_max3_f32 v240, v240, v120, v121
    v_max3_f32 v240, v240, v122, v123
    v_max3_f32 v240, v240, v124, v125
    v_max3_f32 v240, v240, v126, v127
    v_max3_f32 v241, v241, v128, v129
    v_max3_f32 v241, v241, v130, v131
    v_max3_f32 v241, v241, v132, v133
    v_max3_f32 v241, v241, v134, v135
    v_max3_f32 v241, v241, v136, v137
    v_max3_f32 v241, v241, v138, v139
    v_max3_f32 v241, v241, v140, v141
    v_max3_f32 v241, v241, v142, v143
    v_max3_f32 v242, v242, v144, v145
    v_max3_f32 v242, v242, v146, v147
    v_max3_f32 v242, v242, v148, v149
    v_max3_f32 v242, v242, v150, v151
    v_max3_f32 v242, v242, v152, v153
    v_max3_f32 v242, v242, v154, v155
    v_max3_f32 v242, v242, v156, v157
    v_max3_f32 v242, v242, v158, v159
    v_max3_f32 v243, v243, v160, v161
    v_max3_f32 v243, v243, v162, v163
    v_max3_f32 v243, v243, v164, v165
    v_max3_f32 v243, v243, v166, v167
    v_max3_f32 v243, v243, v168, v169
    v_max3_f32 v243, v243, v170, v171
    v_max3_f32 v243, v243, v172, v173
    v_max3_f32 v243, v243, v174, v175
    s_sub_u32 s79, s79, 1
    s_cmp_lg_u32 s79, 0
    s_cbranch_scc1 L_fbl
    s_mov_b32 s33, s77
    buffer_load_dwordx4 v[176:179], v1, s[64:67], s33 offen offset:0 sc1
    buffer_load_dwordx4 v[180:183], v1, s[64:67], s33 offen offset:1024 sc1
    buffer_load_dwordx4 v[184:187], v1, s[64:67], s33 offen offset:2048 sc1
    buffer_load_dwordx4 v[188:191], v1, s[64:67], s33 offen offset:3072 sc1
    s_add_u32 s33, s33, 4096
    buffer_load_dwordx4 v[192:195], v1, s[64:67], s33 offen offset:0 sc1
    buffer_load_dwordx4 v[196:199], v1, s[64:67], s33 offen offset:1024 sc1
    buffer_load_dwordx4 v[200:203], v1, s[64:67], s33 offen offset:2048 sc1
    buffer_load_dwordx4 v[204:207], v1, s[64:67], s33 offen offset:3072 sc1
    s_add_u32 s33, s33, 4096
    buffer_load_dwordx4 v[208:211], v1, s[64:67], s33 offen offset:0 sc1
    buffer_load_dwordx4 v[212:215], v1, s[64:67], s33 offen offset:1024 sc1
    buffer_load_dwordx4 v[216:219], v1, s[64:67], s33 offen offset:2048 sc1
    buffer_load_dwordx4 v[220:223], v1, s[64:67], s33 offen offset:3072 sc1
    s_add_u32 s33, s33, 4096
    v_mov_b32 v232, 0
    v_mov_b32 v233, 0
    v_mov_b32 v234, 0
    v_mov_b32 v235, 0
    v_mov_b32 v236, 0
    v_mov_b32 v237, 0
    v_mov_b32 v238, 0
    v_mov_b32 v239, 0
    s_nop 1
    v_mfma_f32_32x32x16_bf16 v[48:63], v[232:235], v[232:235], 0
    v_mfma_f32_32x32x16_bf16 v[64:79], v[232:235], v[232:235], 0
    v_mfma_f32_32x32x16_bf16 v[80:95], v[232:235], v[232:235], 0
    v_mfma_f32_32x32x16_bf16 v[96:111], v[232:235], v[232:235], 0
    v_mov_b32 v244, v240
    v_mov_b32 v245, v241
    v_mov_b32 v246, v242
    v_mov_b32 v247, v243
    s_nop 0
    v_permlane32_swap_b32 v240, v244
    v_permlane32_swap_b32 v241, v245
    v_permlane32_swap_b32 v242, v246
    v_permlane32_swap_b32 v243, v247
    v_max_f32 v240, v240, v244
    v_max_f32 v241, v241, v245
    v_max_f32 v242, v242, v246
    v_max_f32 v243, v243, v247
    s_mov_b32 vcc_lo, 0x07060302
    v_xor_b32 v8, 0x80000000, v240
    v_and_b32 v9, 0xffff0000, v8
    v_sub_f32 v8, v8, v9
    v_and_b32 v10, 0xffff0000, v8
    v_sub_f32 v8, v8, v10
    v_perm_b32 v9, v10, v9, vcc_lo
    v_lshrrev_b32 v8, 16, v8
    v_cndmask_b32 v22, v22, v9, s[82:83]
    v_cndmask_b32 v23, v23, v8, s[82:83]
    v_xor_b32 v8, 0x80000000, v241
    v_and_b32 v9, 0xffff0000, v8
    v_sub_f32 v8, v8, v9
    v_and_b32 v10, 0xffff0000, v8
    v_sub_f32 v8, v8, v10
    v_perm_b32 v9, v10, v9, vcc_lo
    v_lshrrev_b32 v8, 16, v8
    v_cndmask_b32 v30, v30, v9, s[82:83]
    v_cndmask_b32 v31, v31, v8, s[82:83]
    v_xor_b32 v8, 0x80000000, v242
    v_and_b32 v9, 0xffff0000, v8
    v_sub_f32 v8, v8, v9
    v_and_b32 v10, 0xffff0000, v8
    v_sub_f32 v8, v8, v10
    v_perm_b32 v9, v10, v9, vcc_lo
    v_lshrrev_b32 v8, 16, v8
    v_cndmask_b32 v38, v38, v9, s[82:83]
    v_cndmask_b32 v39, v39, v8, s[82:83]
    v_xor_b32 v8, 0x80000000, v243
    v_and_b32 v9, 0xffff0000, v8
    v_sub_f32 v8, v8, v9
    v_and_b32 v10, 0xffff0000, v8
    v_sub_f32 v8, v8, v10
    v_perm_b32 v9, v10, v9, vcc_lo
    v_lshrrev_b32 v8, 16, v8
    v_cndmask_b32 v46, v46, v9, s[82:83]
    v_cndmask_b32 v47, v47, v8, s[82:83]
    s_waitcnt vmcnt(10)
    v_mfma_f32_32x32x16_bf16 v[112:127], v[176:179], v[16:19], 0
    v_mfma_f32_32x32x16_bf16 v[112:127], v[180:183], v[20:23], v[112:127]
    s_nop 11
    s_branch L_go
    .p2align 6
L_ffn:
    s_sub_u32 s68, s68, 4
    s_waitcnt lgkmcnt(0)
    s_mov_b32 s20, s52
    s_and_b32 s21, s53, 0xffff
    s_mov_b32 s22, 1605632
    s_mov_b32 s23, 0x20000
    s_load_dword s73, s[62:63], 0
    s_mov_b32 s8, s40
    s_and_b32 s9, s41, 0xffff
    s_mov_b32 s10, 1835008
    s_mov_b32 s11, 0x20000
    s_mov_b32 s16, s42
    s_and_b32 s17, s43, 0xffff
    s_mov_b32 s18, 401408
    s_mov_b32 s19, 0x20000
    v_lshlrev_b32 v224, 7, v0
    s_lshl_b32 s4, s2, 2
    s_add_u32 s4, s4, s68
    s_mul_i32 s5, s4, 1792
    s_lshl_b32 s4, s4, 9
    s_mov_b64 exec, 15
    buffer_load_dword v226, v224, s[16:19], s4 offen
    s_mov_b64 exec, 0x3fff
    buffer_load_dword v227, v224, s[8:11], s5 offen
    s_mov_b64 exec, -1
    v_lshlrev_b32 v224, 7, v0
    s_lshl_b32 s4, s2, 2
    s_add_u32 s4, s4, s68
    s_mul_i32 s5, s4, 1664
    s_mov_b64 exec, 0x1fff
    buffer_load_dword v225, v224, s[20:23], s5 offen
    s_mov_b64 exec, -1
    v_add_u32 v14, 0, v0
    v_mul_u32_u24 v15, 4682, v14
    v_lshrrev_b32 v15, 16, v15
    v_mul_u32_u24 v48, 14, v15
    v_sub_u32 v14, v14, v48
    v_bfe_u32 v48, v15, 2, 2
    v_and_b32 v49, 3, v15
    v_lshl_add_u32 v49, v48, 3, v49
    v_lshrrev_b32 v15, 4, v15
    v_lshl_add_u32 v49, v15, 2, v49
    v_mul_u32_u24 v49, 3584, v49
    v_lshl_add_u32 v5, v14, 4, v49
    v_add_u32 v14, 64, v0
    v_mul_u32_u24 v15, 4682, v14
    v_lshrrev_b32 v15, 16, v15
    v_mul_u32_u24 v48, 14, v15
    v_sub_u32 v14, v14, v48
    v_bfe_u32 v48, v15, 2, 2
    v_and_b32 v49, 3, v15
    v_lshl_add_u32 v49, v48, 3, v49
    v_lshrrev_b32 v15, 4, v15
    v_lshl_add_u32 v49, v15, 2, v49
    v_mul_u32_u24 v49, 3584, v49
    v_lshl_add_u32 v6, v14, 4, v49
    v_add_u32 v14, 128, v0
    v_mul_u32_u24 v15, 4682, v14
    v_lshrrev_b32 v15, 16, v15
    v_mul_u32_u24 v48, 14, v15
    v_sub_u32 v14, v14, v48
    v_bfe_u32 v48, v15, 2, 2
    v_and_b32 v49, 3, v15
    v_lshl_add_u32 v49, v48, 3, v49
    v_lshrrev_b32 v15, 4, v15
    v_lshl_add_u32 v49, v15, 2, v49
    v_mul_u32_u24 v49, 3584, v49
    v_lshl_add_u32 v7, v14, 4, v49
    v_add_u32 v14, 192, v0
    v_mul_u32_u24 v15, 4682, v14
    v_lshrrev_b32 v15, 16, v15
    v_mul_u32_u24 v48, 14, v15
    v_sub_u32 v14, v14, v48
    v_bfe_u32 v48, v15, 2, 2
    v_and_b32 v49, 3, v15
    v_lshl_add_u32 v49, v48, 3, v49
    v_lshrrev_b32 v15, 4, v15
    v_lshl_add_u32 v49, v15, 2, v49
    v_mul_u32_u24 v49, 3584, v49
    v_lshl_add_u32 v8, v14, 4, v49
    v_add_u32 v14, 256, v0
    v_mul_u32_u24 v15, 4682, v14
    v_lshrrev_b32 v15, 16, v15
    v_mul_u32_u24 v48, 14, v15
    v_sub_u32 v14, v14, v48
    v_bfe_u32 v48, v15, 2, 2
    v_and_b32 v49, 3, v15
    v_lshl_add_u32 v49, v48, 3, v49
    v_lshrrev_b32 v15, 4, v15
    v_lshl_add_u32 v49, v15, 2, v49
    v_mul_u32_u24 v49, 3584, v49
    v_lshl_add_u32 v9, v14, 4, v49
    v_add_u32 v14, 320, v0
    v_mul_u32_u24 v15, 4682, v14
    v_lshrrev_b32 v15, 16, v15
    v_mul_u32_u24 v48, 14, v15
    v_sub_u32 v14, v14, v48
    v_bfe_u32 v48, v15, 2, 2
    v_and_b32 v49, 3, v15
    v_lshl_add_u32 v49, v48, 3, v49
    v_lshrrev_b32 v15, 4, v15
    v_lshl_add_u32 v49, v15, 2, v49
    v_mul_u32_u24 v49, 3584, v49
    v_lshl_add_u32 v10, v14, 4, v49
    v_add_u32 v14, 384, v0
    v_mul_u32_u24 v15, 4682, v14
    v_lshrrev_b32 v15, 16, v15
    v_mul_u32_u24 v48, 14, v15
    v_sub_u32 v14, v14, v48
    v_bfe_u32 v48, v15, 2, 2
    v_and_b32 v49, 3, v15
    v_lshl_add_u32 v49, v48, 3, v49
    v_lshrrev_b32 v15, 4, v15
    v_lshl_add_u32 v49, v15, 2, v49
    v_mul_u32_u24 v49, 3584, v49
    v_lshl_add_u32 v11, v14, 4, v49
    s_mul_i32 s80, s70, 224
    s_mul_i32 s77, s68, 28672
    s_add_u32 s81, s81, s68
    s_mov_b32 s12, s62
    s_and_b32 s13, s63, 0xffff
    s_mov_b32 s14, 16777216
    s_mov_b32 s15, 0x20000
    s_mov_b32 s28, s54
    s_and_b32 s29, s55, 0xffff
    s_mov_b32 s30, 1605632
    s_mov_b32 s31, 0x20000
    s_mov_b32 s32, s48
    s_and_b32 s33, s49, 0xffff
    s_mov_b32 s34, 401408
    s_mov_b32 s35, 0x20000
    s_mov_b32 s36, s58
    s_and_b32 s37, s59, 0xffff
    s_mov_b32 s38, 1835008
    s_mov_b32 s39, 0x20000
    v_lshlrev_b32 v224, 7, v0
    s_lshl_b32 s4, s2, 2
    s_add_u32 s4, s4, s68
    s_mul_i32 s5, s4, 1664
    s_lshl_b32 s4, s4, 9
    s_mov_b64 exec, 0x1fff
    buffer_load_dword v226, v224, s[28:31], s5 offen
    s_mov_b64 exec, 15
    buffer_load_dword v227, v224, s[32:35], s4 offen
    s_mov_b64 exec, -1
    s_waitcnt lgkmcnt(0)
    s_mul_i32 s3, s73, 0x9E3779B1
    s_add_u32 s3, s3, 0x7F4A7C15
    s_xor_b32 s73, s73, s3
    s_and_b32 s73, s73, 0x3fff0000
    s_cselect_b32 s73, 0, 0x10000
    s_xor_b32 s73, s73, s3
    s_barrier
    s_add_u32 s76, s81, 0
    s_sub_u32 s79, s76, 14
    s_cselect_b32 s76, s76, s79
    s_mul_i32 s76, s76, 114688
    s_add_u32 s76, s76, s80
    s_add_u32 m0, s77, 0
    s_nop 0
    buffer_load_dwordx4 v5, s[20:23], s76 offen lds
    s_add_u32 m0, s77, 1024
    s_nop 0
    buffer_load_dwordx4 v6, s[20:23], s76 offen lds
    s_add_u32 m0, s77, 2048
    s_nop 0
    buffer_load_dwordx4 v7, s[20:23], s76 offen lds
    s_add_u32 m0, s77, 3072
    s_nop 0
    buffer_load_dwordx4 v8, s[20:23], s76 offen lds
    s_add_u32 m0, s77, 4096
    s_nop 0
    buffer_load_dwordx4 v9, s[20:23], s76 offen lds
    s_add_u32 m0, s77, 5120
    s_nop 0
    buffer_load_dwordx4 v10, s[20:23], s76 offen lds
    s_add_u32 m0, s77, 6144
    s_nop 0
    buffer_load_dwordx4 v11, s[20:23], s76 offen lds
    s_add_u32 s76, s81, 4
    s_sub_u32 s79, s76, 14
    s_cselect_b32 s76, s76, s79
    s_mul_i32 s76, s76, 114688
    s_add_u32 s76, s76, s80
    s_add_u32 m0, s77, 7168
    s_nop 0
    buffer_load_dwordx4 v5, s[20:23], s76 offen lds
    s_add_u32 m0, s77, 8192
    s_nop 0
    buffer_load_dwordx4 v6, s[20:23], s76 offen lds
    s_add_u32 m0, s77, 9216
    s_nop 0
    buffer_load_dwordx4 v7, s[20:23], s76 offen lds
    s_add_u32 m0, s77, 10240
    s_nop 0
    buffer_load_dwordx4 v8, s[20:23], s76 offen lds
    s_add_u32 m0, s77, 11264
    s_nop 0
    buffer_load_dwordx4 v9, s[20:23], s76 offen lds
    s_add_u32 m0, s77, 12288
    s_nop 0
    buffer_load_dwordx4 v10, s[20:23], s76 offen lds
    s_add_u32 m0, s77, 13312
    s_nop 0
    buffer_load_dwordx4 v11, s[20:23], s76 offen lds
    s_waitcnt vmcnt(7)
    s_cmp_eq_u32 s68, 3
    s_cbranch_scc1 L_pub
    s_barrier
    s_add_u32 s76, s81, 8
    s_sub_u32 s79, s76, 14
    s_cselect_b32 s76, s76, s79
    s_mul_i32 s76, s76, 114688
    s_add_u32 s76, s76, s80
    s_add_u32 m0, s77, 14336
    s_nop 0
    buffer_load_dwordx4 v5, s[20:23], s76 offen lds
    s_add_u32 m0, s77, 15360
    s_nop 0
    buffer_load_dwordx4 v6, s[20:23], s76 offen lds
    s_add_u32 m0, s77, 16384
    s_nop 0
    buffer_load_dwordx4 v7, s[20:23], s76 offen lds
    s_add_u32 m0, s77, 17408
    s_nop 0
    buffer_load_dwordx4 v8, s[20:23], s76 offen lds
    s_add_u32 m0, s77, 18432
    s_nop 0
    buffer_load_dwordx4 v9, s[20:23], s76 offen lds
    s_add_u32 m0, s77, 19456
    s_nop 0
    buffer_load_dwordx4 v10, s[20:23], s76 offen lds
    s_add_u32 m0, s77, 20480
    s_nop 0
    buffer_load_dwordx4 v11, s[20:23], s76 offen lds
    s_waitcnt vmcnt(7)
    s_barrier
    s_cmp_ge_u32 s68, 2
    s_cbranch_scc1 L_pubd
    s_add_u32 s76, s81, 12
    s_sub_u32 s79, s76, 14
    s_cselect_b32 s76, s76, s79
    s_mul_i32 s76, s76, 114688
    s_add_u32 s76, s76, s80
    s_add_u32 m0, s77, 21504
    s_nop 0
    buffer_load_dwordx4 v5, s[20:23], s76 offen lds
    s_add_u32 m0, s77, 22528
    s_nop 0
    buffer_load_dwordx4 v6, s[20:23], s76 offen lds
    s_add_u32 m0, s77, 23552
    s_nop 0
    buffer_load_dwordx4 v7, s[20:23], s76 offen lds
    s_add_u32 m0, s77, 24576
    s_nop 0
    buffer_load_dwordx4 v8, s[20:23], s76 offen lds
    s_add_u32 m0, s77, 25600
    s_nop 0
    buffer_load_dwordx4 v9, s[20:23], s76 offen lds
    s_add_u32 m0, s77, 26624
    s_nop 0
    buffer_load_dwordx4 v10, s[20:23], s76 offen lds
    s_add_u32 m0, s77, 27648
    s_nop 0
    buffer_load_dwordx4 v11, s[20:23], s76 offen lds
    s_branch L_pubd
L_pub:
    s_lshl_b32 s75, s69, 14
    s_add_u32 s75, s75, 65536
    s_cmp_eq_u32 s70, 14
    s_cbranch_scc1 L_pubk
    s_cmp_ge_u32 s70, 7
    s_cbranch_scc1 L_pubv
L_pubk:
    s_min_u32 s76, s70, 7
    s_lshr_b32 s77, s76, 1
    s_lshl_b32 s77, s77, 9
    s_add_u32 s75, s75, s77
    s_and_b32 s77, s76, 1
    s_lshl_b32 s77, s77, 3
    s_add_u32 s75, s75, s77
    s_add_u32 s76, s75, 8192
    v_lshrrev_b32 v14, 5, v0
    v_and_b32 v15, 31, v0
    v_lshlrev_b32 v15, 4, v15
    v_lshl_add_u32 v14, v14, 12, v15
    v_mul_u32_u24 v15, 80, v0
    v_add_u32 v15, 153656, v15
    s_barrier
    ds_read_b64 v[16:17], v15
    ds_read_b64 v[18:19], v15 offset:5120
    s_cmp_eq_u32 s70, 14
    s_cbranch_scc1 L_pubg
    s_waitcnt lgkmcnt(0)
    buffer_store_dwordx2 v[16:17], v14, s[12:15], s75 offen sc1
    buffer_store_dwordx2 v[18:19], v14, s[12:15], s76 offen sc1
    s_waitcnt vmcnt(2)
    s_branch L_pubf
L_pubg:
    v_mov_b32 v20, 0x3f803f80
    v_mov_b32 v21, 0x3f80
    s_lshl_b32 s77, s69, 9
    s_add_u32 s77, s77, 16384
    buffer_store_dwordx2 v[20:21], v14, s[12:15], s75 offen sc1
    buffer_store_dwordx2 v[20:21], v14, s[12:15], s76 offen sc1
    v_lshlrev_b32 v22, 2, v0
    s_waitcnt lgkmcnt(0)
    v_lshlrev_b32 v16, 16, v16
    v_lshlrev_b32 v18, 16, v18
    v_mul_f32 v16, 0xbfb8aa3b, v16
    v_mul_f32 v18, 0xbfb8aa3b, v18
    v_exp_f32 v16, v16
    v_exp_f32 v18, v18
    s_nop 0
    v_add_f32 v16, 1.0, v16
    v_add_f32 v18, 1.0, v18
    v_rcp_f32 v16, v16
    v_rcp_f32 v18, v18
    s_nop 1
    buffer_store_dword v16, v22, s[12:15], s77 offen sc1
    buffer_store_dword v18, v22, s[12:15], s77 offen offset:256 sc1
    s_waitcnt vmcnt(4)
    s_branch L_pubf
L_pubv:
    v_and_b32 v14, 3, v0
    v_lshrrev_b32 v15, 2, v0
    v_mul_u32_u24 v22, 640, v15
    v_lshl_add_u32 v22, v14, 1, v22
    v_add_u32 v22, 153656, v22
    v_lshrrev_b32 v23, 2, v15
    v_and_b32 v15, 3, v15
    v_lshlrev_b32 v15, 9, v15
    v_lshl_add_u32 v23, v23, 12, v15
    s_cmp_eq_u32 s70, 15
    s_cbranch_scc1 L_pubo
    s_sub_u32 s76, s70, 7
    s_lshl_b32 s76, s76, 2
    v_add_u32 v14, s76, v14
    v_cmp_le_u32 vcc, 14, v14
    s_nop 1
    v_cndmask_b32 v15, 0, 1, vcc
    v_mul_u32_u24 v24, 14, v15
    v_sub_u32 v14, v14, v24
    v_cmp_le_u32 vcc, 7, v14
    s_nop 1
    v_cndmask_b32 v24, 0, 1, vcc
    v_add_u32 v14, v14, v24
    v_lshrrev_b32 v24, 2, v14
    v_and_b32 v14, 3, v14
    v_lshl_add_u32 v14, v24, 3, v14
    v_lshl_add_u32 v14, v15, 2, v14
    v_lshl_add_u32 v23, v14, 4, v23
    s_mov_b32 vcc_lo, 0x05040100
    s_barrier
    ds_read_u16 v24, v22 offset:0
    ds_read_u16 v25, v22 offset:80
    ds_read_u16 v26, v22 offset:160
    ds_read_u16 v27, v22 offset:240
    ds_read_u16 v28, v22 offset:320
    ds_read_u16 v29, v22 offset:400
    ds_read_u16 v30, v22 offset:480
    ds_read_u16 v31, v22 offset:560
    s_waitcnt lgkmcnt(0)
    v_perm_b32 v16, v25, v24, vcc_lo
    v_perm_b32 v17, v27, v26, vcc_lo
    v_perm_b32 v18, v29, v28, vcc_lo
    v_perm_b32 v19, v31, v30, vcc_lo
    s_branch L_pubs
L_pubo:
    v_and_b32 v15, 1, v14
    v_lshrrev_b32 v14, 1, v14
    v_lshlrev_b32 v14, 4, v14
    v_lshl_add_u32 v14, v15, 2, v14
    v_add_u32 v14, 11, v14
    v_lshl_add_u32 v23, v14, 4, v23
    v_mov_b32 v16, 0x3f803f80
    v_mov_b32 v17, 0x3f803f80
    v_mov_b32 v18, 0x3f803f80
    v_mov_b32 v19, 0x3f803f80
    s_barrier
L_pubs:
    buffer_store_dwordx4 v[16:19], v23, s[12:15], s75 offen offset:2048 sc1
    s_waitcnt vmcnt(1)
L_pubf:
    s_mul_i32 s77, s68, 28672
    s_add_u32 s76, s81, 8
    s_sub_u32 s79, s76, 14
    s_cselect_b32 s76, s76, s79
    s_mul_i32 s76, s76, 114688
    s_add_u32 s76, s76, s80
    s_add_u32 m0, s77, 14336
    s_nop 0
    buffer_load_dwordx4 v5, s[20:23], s76 offen lds
    s_add_u32 m0, s77, 15360
    s_nop 0
    buffer_load_dwordx4 v6, s[20:23], s76 offen lds
    s_add_u32 m0, s77, 16384
    s_nop 0
    buffer_load_dwordx4 v7, s[20:23], s76 offen lds
    s_add_u32 m0, s77, 17408
    s_nop 0
    buffer_load_dwordx4 v8, s[20:23], s76 offen lds
    s_add_u32 m0, s77, 18432
    s_nop 0
    buffer_load_dwordx4 v9, s[20:23], s76 offen lds
    s_add_u32 m0, s77, 19456
    s_nop 0
    buffer_load_dwordx4 v10, s[20:23], s76 offen lds
    s_add_u32 m0, s77, 20480
    s_nop 0
    buffer_load_dwordx4 v11, s[20:23], s76 offen lds
    s_lshl_b32 s75, s69, 4
    s_add_u32 s75, s75, s70
    s_lshl_b32 s75, s75, 7
    s_add_u32 s75, s75, 32768
    s_waitcnt vmcnt(7)
    v_mov_b32 v16, s73
    s_mov_b64 exec, 1
    buffer_store_dword v16, off, s[12:15], s75 sc1
    s_mov_b64 exec, -1
    s_barrier
L_pubd:
    v_lshlrev_b32 v224, 7, v0
    s_lshl_b32 s75, s74, 2
    s_add_u32 s75, s75, s68
    s_mul_i32 s76, s75, 12544
    s_add_u32 s78, s76, 8192
    s_mul_i32 s75, s75, 3136
    v_lshlrev_b32 v1, 4, v0
    v_lshrrev_b32 v12, 3, v0
    v_and_b32 v13, 7, v0
    v_bfe_u32 v14, v0, 4, 1
    v_lshlrev_b32 v14, 2, v14
    v_xor_b32 v13, v13, v14
    v_mul_u32_u24 v2, 896, v12
    v_lshl_add_u32 v2, v13, 4, v2
    v_cmp_eq_u32 vcc, 7, v12
    v_mov_b32 v14, 0x40000000
    s_nop 0
    v_cndmask_b32 v3, v2, v14, vcc
    s_mul_i32 s75, s68, 28672
    v_bfe_u32 v12, v0, 3, 1
    s_and_b32 s79, s68, 1
    v_xor_b32 v12, s79, v12
    v_lshlrev_b32 v12, 6, v12
    v_bfe_u32 v13, v0, 4, 1
    v_lshl_add_u32 v12, v13, 5, v12
    v_and_b32 v13, 3, v0
    v_lshl_add_u32 v12, v13, 3, v12
    v_bfe_u32 v13, v0, 2, 2
    v_lshl_add_u32 v12, v13, 7, v12
    v_add_u32 v12, s75, v12
    v_lshrrev_b32 v13, 5, v0
    v_lshl_add_u32 v4, v13, 9, v12
    v_xor_b32 v5, 64, v4
    v_lshl_add_u32 v6, v13, 10, v12
    v_xor_b32 v7, 64, v6
    s_lshl_b32 s3, s68, 13
    s_add_u32 s3, s3, 114688
    s_sub_u32 s4, s3, s75
    v_add_u32 v230, s4, v4
    v_add_u32 v231, s4, v5
    v_add_u32 v232, s4, v6
    v_add_u32 v233, s4, v7
    v_and_b32 v12, 31, v0
    v_lshlrev_b32 v10, 2, v12
    v_mul_u32_u24 v11, 896, v12
    v_lshl_add_u32 v11, v13, 4, v11
    v_bfe_u32 v12, v0, 2, 1
    v_and_b32 v13, 3, v0
    v_lshl_add_u32 v12, v12, 4, v13
    s_lshl_b32 s79, s71, 5
    s_lshl_b32 s76, s68, 2
    s_add_u32 s79, s79, s76
    v_add_lshl_u32 v12, v12, s79, 7
    v_add_u32 v9, 2752512, v12
    v_add_u32 v8, 2621440, v12
    s_mul_i32 s76, s68, 401408
    s_lshl_b32 s79, s72, 7
    s_add_u32 s76, s76, s79
    s_mul_i32 s80, s68, 100352
    s_add_u32 s80, s80, s79
    s_lshr_b32 s79, s68, 1
    s_lshl_b32 s71, s71, 1
    s_add_u32 s71, s71, s79
    s_mul_i32 s79, s68, 28672
    s_add_u32 s79, s79, 3145728
    s_mul_i32 s77, s71, 114688
    s_add_u32 s77, s77, s79
    s_xor_b32 s78, s71, 1
    s_mul_i32 s78, s78, 114688
    s_add_u32 s78, s78, s79
    s_lshl_b32 s64, s71, 15
    s_lshl_b32 s79, s68, 13
    s_add_u32 s64, s64, s79
    s_add_u32 s64, s64, 524288
    s_xor_b32 s65, s64, 0x8000
    s_lshl_b32 s79, s68, 13
    s_add_u32 s79, s79, 32768
    v_add_u32 v12, s79, v224
    s_cmp_eq_u32 s68, 3
    s_waitcnt vmcnt(1)
    s_cbranch_scc1 L_pube
    s_waitcnt vmcnt(0)
L_pube:
    s_barrier
    s_mov_b32 s79, 0x20000
L_pw1:
    buffer_load_dword v228, v12, s[12:15], 0 offen sc1
    s_sub_u32 s79, s79, 1
    s_cbranch_scc1 L_pd1
    s_waitcnt vmcnt(0)
    v_cmp_ne_u32 vcc, s73, v228
    s_nop 1
    s_cbranch_vccz L_pd1
    s_mov_b64 exec, vcc
    s_branch L_pw1
L_pd1:
    s_mov_b64 exec, -1
    s_lshl_b32 s79, s68, 5
    s_add_u32 s79, s79, s74
    s_lshl_b32 s79, s79, 11
    s_add_u32 s79, s79, 65536
    s_lshl_b32 s79, s72, 12
    v_and_b32 v224, 0xf80, v224
    v_mov_b32 v12, s77
    v_mov_b32 v13, s78
    v_add_u32 v224, s79, v224
    v_cndmask_b32 v12, v12, v13, s[82:83]
    v_add_u32 v224, v224, v12
    s_barrier
    s_or_b32 s79, s2, s68
    s_cmp_lg_u32 s79, 0
    s_cbranch_scc1 L_noep
    v_mov_b32 v228, s73
    s_mov_b64 exec, 1
    buffer_store_dword v228, off, s[12:15], s79 sc1
    s_mov_b64 exec, -1
L_noep:
    s_cmp_ge_u32 s74, 28
    s_cbranch_scc1 L_idle
    s_add_u32 m0, s75, 0
    s_add_u32 s4, s80, 50176
    buffer_load_dwordx4 v3, s[32:35], s4 offen lds
    s_add_u32 m0, s75, 1024
    s_add_u32 s4, s80, 62720
    buffer_load_dwordx4 v3, s[32:35], s4 offen lds
    s_add_u32 m0, s75, 2048
    s_add_u32 s4, s80, 56448
    buffer_load_dwordx4 v3, s[32:35], s4 offen lds
    s_add_u32 m0, s75, 3072
    s_add_u32 s4, s80, 68992
    buffer_load_dwordx4 v3, s[32:35], s4 offen lds
    s_add_u32 m0, s75, 4096
    s_add_u32 s4, s80, 75264
    buffer_load_dwordx4 v3, s[32:35], s4 offen lds
    s_add_u32 m0, s75, 5120
    s_add_u32 s4, s80, 87808
    buffer_load_dwordx4 v3, s[32:35], s4 offen lds
    s_add_u32 m0, s75, 6144
    s_add_u32 s4, s80, 81536
    buffer_load_dwordx4 v3, s[32:35], s4 offen lds
    s_add_u32 m0, s75, 7168
    s_add_u32 s4, s80, 94080
    s_waitcnt vmcnt(6)
    buffer_load_dwordx4 v3, s[32:35], s4 offen lds
    s_add_u32 m0, s75, 8192
    s_nop 0
    s_waitcnt vmcnt(6)
    buffer_load_dwordx4 v2, s[28:31], s76 offen lds
    s_add_u32 s76, s76, 7168
    s_add_u32 m0, s75, 9216
    s_nop 0
    s_waitcnt vmcnt(6)
    buffer_load_dwordx4 v2, s[28:31], s76 offen lds
    s_add_u32 s76, s76, 7168
    s_add_u32 m0, s75, 10240
    s_nop 0
    s_waitcnt vmcnt(6)
    buffer_load_dwordx4 v2, s[28:31], s76 offen lds
    s_add_u32 s76, s76, 7168
    s_add_u32 m0, s75, 11264
    s_nop 0
    s_waitcnt vmcnt(6)
    buffer_load_dwordx4 v2, s[28:31], s76 offen lds
    s_add_u32 s76, s76, 7168
    s_add_u32 m0, s75, 12288
    s_nop 0
    s_waitcnt vmcnt(6)
    buffer_load_dwordx4 v2, s[28:31], s76 offen lds
    s_add_u32 s76, s76, 7168
    s_add_u32 m0, s75, 13312
    s_nop 0
    s_waitcnt vmcnt(6)
    buffer_load_dwordx4 v2, s[28:31], s76 offen lds
    s_add_u32 s76, s76, 7168
    s_add_u32 m0, s3, 0
    s_nop 0
    s_waitcnt vmcnt(6)
    buffer_load_dwordx4 v2, s[28:31], s76 offen lds
    s_add_u32 s76, s76, 7168
    s_add_u32 m0, s3, 1024
    s_nop 0
    s_waitcnt vmcnt(6)
    buffer_load_dwordx4 v2, s[28:31], s76 offen lds
    s_add_u32 s76, s76, 7168
    s_add_u32 m0, s3, 2048
    s_nop 0
    s_waitcnt vmcnt(6)
    buffer_load_dwordx4 v2, s[28:31], s76 offen lds
    s_add_u32 s76, s76, 7168
    s_add_u32 m0, s3, 3072
    s_nop 0
    s_waitcnt vmcnt(6)
    buffer_load_dwordx4 v2, s[28:31], s76 offen lds
    s_add_u32 s76, s76, 7168
    s_add_u32 m0, s3, 4096
    s_nop 0
    s_waitcnt vmcnt(6)
    buffer_load_dwordx4 v2, s[28:31], s76 offen lds
    s_add_u32 s76, s76, 7168
    s_add_u32 m0, s3, 5120
    s_nop 0
    s_waitcnt vmcnt(6)
    buffer_load_dwordx4 v2, s[28:31], s76 offen lds
    s_add_u32 s76, s76, 7168
    s_add_u32 m0, s3, 6144
    s_nop 0
    s_waitcnt vmcnt(6)
    buffer_load_dwordx4 v2, s[28:31], s76 offen lds
    s_add_u32 s76, s76, 7168
    s_add_u32 m0, s3, 7168
    s_nop 0
    s_waitcnt vmcnt(6)
    buffer_load_dwordx4 v2, s[28:31], s76 offen lds
    s_add_u32 s76, s76, 7168
    s_waitcnt vmcnt(20)
    ds_read_b64_tr_b16 v[176:177], v6 offset:0
    ds_read_b64_tr_b16 v[178:179], v6 offset:512
    ds_read_b64_tr_b16 v[180:181], v7 offset:0
    ds_read_b64_tr_b16 v[182:183], v7 offset:512
    s_waitcnt vmcnt(18)
    ds_read_b64_tr_b16 v[184:185], v6 offset:2048
    ds_read_b64_tr_b16 v[186:187], v6 offset:2560
    ds_read_b64_tr_b16 v[188:189], v7 offset:2048
    ds_read_b64_tr_b16 v[190:191], v7 offset:2560
    s_waitcnt vmcnt(16) lgkmcnt(4)
    ds_read_b64_tr_b16 v[192:193], v6 offset:4096
    ds_read_b64_tr_b16 v[194:195], v6 offset:4608
    ds_read_b64_tr_b16 v[196:197], v7 offset:4096
    ds_read_b64_tr_b16 v[198:199], v7 offset:4608
    s_add_u32 m0, s75, 0
    s_nop 0
    s_waitcnt vmcnt(6)
    buffer_load_dwordx4 v2, s[28:31], s76 offen lds
    s_add_u32 s76, s76, 7168
    s_add_u32 m0, s75, 1024
    s_nop 0
    s_waitcnt vmcnt(6)
    buffer_load_dwordx4 v2, s[28:31], s76 offen lds
    s_add_u32 s76, s76, 7168
    s_waitcnt vmcnt(16) lgkmcnt(4)
    ds_read_b64_tr_b16 v[200:201], v6 offset:6144
    ds_read_b64_tr_b16 v[202:203], v6 offset:6656
    ds_read_b64_tr_b16 v[204:205], v7 offset:6144
    ds_read_b64_tr_b16 v[206:207], v7 offset:6656
    s_add_u32 m0, s75, 2048
    s_nop 0
    s_waitcnt vmcnt(6)
    buffer_load_dwordx4 v2, s[28:31], s76 offen lds
    s_add_u32 s76, s76, 7168
    s_add_u32 m0, s75, 3072
    s_nop 0
    s_waitcnt vmcnt(6)
    buffer_load_dwordx4 v2, s[28:31], s76 offen lds
    s_add_u32 s76, s76, 7168
    s_waitcnt lgkmcnt(0)
    s_add_u32 m0, s75, 4096
    s_nop 0
    s_waitcnt vmcnt(6)
    buffer_load_dwordx4 v2, s[28:31], s76 offen lds
    s_add_u32 s76, s76, 7168
    s_add_u32 m0, s75, 5120
    s_nop 0
    s_waitcnt vmcnt(6)
    buffer_load_dwordx4 v2, s[28:31], s76 offen lds
    s_add_u32 s76, s76, 7168
    s_add_u32 m0, s75, 6144
    s_nop 0
    s_waitcnt vmcnt(6)
    buffer_load_dwordx4 v2, s[28:31], s76 offen lds
    s_add_u32 s76, s76, 7168
    s_add_u32 m0, s75, 7168
    s_nop 0
    s_waitcnt vmcnt(6)
    buffer_load_dwordx4 v2, s[28:31], s76 offen lds
    s_add_u32 s76, s76, 7168
    s_mov_b32 s79, 0x20000
L_pw2:
    buffer_load_dword v12, v8, s[12:15], 0 offen sc1
    s_sub_u32 s79, s79, 1
    s_cbranch_scc1 L_pd2
    s_waitcnt vmcnt(0)
    v_cmp_ne_u32 vcc, s73, v12
    s_nop 1
    s_cbranch_vccz L_pd2
    s_mov_b64 exec, vcc
    s_branch L_pw2
L_pd2:
    s_mov_b64 exec, -1
    s_lshl_b32 s79, s71, 7
    s_add_u32 s79, s79, 16384
    buffer_load_dword v14, v10, s[12:15], s79 offen sc1
    s_xor_b32 s79, s79, 128
    buffer_load_dword v15, v10, s[12:15], s79 offen sc1
    buffer_load_dwordx4 v[80:83], v1, s[12:15], s77 offen offset:0 sc1
    buffer_load_dwordx4 v[84:87], v1, s[12:15], s78 offen offset:0 sc1
    buffer_load_dwordx4 v[88:91], v1, s[12:15], s77 offen offset:1024 sc1
    buffer_load_dwordx4 v[92:95], v1, s[12:15], s78 offen offset:1024 sc1
    buffer_load_dwordx4 v[96:99], v1, s[12:15], s77 offen offset:2048 sc1
    s_waitcnt vmcnt(6)
    buffer_load_dwordx4 v[100:103], v1, s[12:15], s78 offen offset:2048 sc1
    s_waitcnt vmcnt(6)
    buffer_load_dwordx4 v[104:107], v1, s[12:15], s77 offen offset:3072 sc1
    s_waitcnt vmcnt(6)
    buffer_load_dwordx4 v[108:111], v1, s[12:15], s78 offen offset:3072 sc1
    s_add_u32 s77, s77, 4096
    s_add_u32 s78, s78, 4096
    s_waitcnt vmcnt(6)
    buffer_load_dwordx4 v[112:115], v1, s[12:15], s77 offen offset:0 sc1
    s_waitcnt vmcnt(6)
    buffer_load_dwordx4 v[116:119], v1, s[12:15], s78 offen offset:0 sc1
    s_waitcnt vmcnt(6)
    buffer_load_dwordx4 v[120:123], v1, s[12:15], s77 offen offset:1024 sc1
    s_waitcnt vmcnt(6)
    buffer_load_dwordx4 v[124:127], v1, s[12:15], s78 offen offset:1024 sc1
    s_waitcnt vmcnt(6)
    buffer_load_dwordx4 v[128:131], v1, s[12:15], s77 offen offset:2048 sc1
    s_waitcnt vmcnt(6)
    buffer_load_dwordx4 v[132:135], v1, s[12:15], s78 offen offset:2048 sc1
    s_waitcnt vmcnt(6)
    buffer_load_dwordx4 v[136:139], v1, s[12:15], s77 offen offset:3072 sc1
    s_waitcnt vmcnt(6)
    buffer_load_dwordx4 v[140:143], v1, s[12:15], s78 offen offset:3072 sc1
    s_add_u32 s77, s77, 4096
    s_add_u32 s78, s78, 4096
    s_waitcnt vmcnt(6)
    buffer_load_dwordx4 v[144:147], v1, s[12:15], s77 offen offset:0 sc1
    s_waitcnt vmcnt(6)
    buffer_load_dwordx4 v[148:151], v1, s[12:15], s78 offen offset:0 sc1
    s_waitcnt vmcnt(6)
    buffer_load_dwordx4 v[152:155], v1, s[12:15], s77 offen offset:1024 sc1
    s_waitcnt vmcnt(6)
    buffer_load_dwordx4 v[156:159], v1, s[12:15], s78 offen offset:1024 sc1
    s_waitcnt vmcnt(6)
    buffer_load_dwordx4 v[160:163], v1, s[12:15], s77 offen offset:2048 sc1
    s_waitcnt vmcnt(6)
    buffer_load_dwordx4 v[164:167], v1, s[12:15], s78 offen offset:2048 sc1
    s_waitcnt vmcnt(6)
    buffer_load_dwordx4 v[168:171], v1, s[12:15], s77 offen offset:3072 sc1
    s_waitcnt vmcnt(6)
    buffer_load_dwordx4 v[172:175], v1, s[12:15], s78 offen offset:3072 sc1
    s_add_u32 s77, s77, 4096
    s_add_u32 s78, s78, 4096
    ds_read_b64_tr_b16 v[208:209], v4 offset:8192
    ds_read_b64_tr_b16 v[210:211], v4 offset:10240
    ds_read_b64_tr_b16 v[212:213], v5 offset:8192
    ds_read_b64_tr_b16 v[214:215], v5 offset:10240
    ds_read_b64_tr_b16 v[216:217], v4 offset:9216
    ds_read_b64_tr_b16 v[218:219], v4 offset:11264
    ds_read_b64_tr_b16 v[220:221], v5 offset:9216
    ds_read_b64_tr_b16 v[222:223], v5 offset:11264
    ds_read_b64_tr_b16 v[234:235], v4 offset:12288
    ds_read_b64_tr_b16 v[236:237], v230 offset:0
    ds_read_b64_tr_b16 v[238:239], v5 offset:12288
    ds_read_b64_tr_b16 v[240:241], v231 offset:0
    s_waitcnt vmcnt(22) lgkmcnt(8)
    v_mfma_f32_32x32x16_bf16 v[16:31], v[208:211], v[80:83], 0
    ds_read_b64_tr_b16 v[242:243], v4 offset:13312
    ds_read_b64_tr_b16 v[244:245], v230 offset:1024
    v_mfma_f32_32x32x16_bf16 v[32:47], v[212:215], v[80:83], 0
    ds_read_b64_tr_b16 v[246:247], v5 offset:13312
    ds_read_b64_tr_b16 v[248:249], v231 offset:1024
    v_mfma_f32_32x32x16_bf16 v[48:63], v[208:211], v[84:87], 0
    v_mfma_f32_32x32x16_bf16 v[64:79], v[212:215], v[84:87], 0
    s_waitcnt vmcnt(6)
    buffer_load_dwordx4 v[80:83], v1, s[12:15], s77 offen offset:0 sc1
    s_waitcnt vmcnt(6)
    buffer_load_dwordx4 v[84:87], v1, s[12:15], s78 offen offset:0 sc1
    s_waitcnt vmcnt(22) lgkmcnt(8)
    v_mfma_f32_32x32x16_bf16 v[16:31], v[216:219], v[88:91], v[16:31]
    ds_read_b64_tr_b16 v[208:209], v230 offset:2048
    ds_read_b64_tr_b16 v[210:211], v230 offset:4096
    v_mfma_f32_32x32x16_bf16 v[32:47], v[220:223], v[88:91], v[32:47]
    ds_read_b64_tr_b16 v[212:213], v231 offset:2048
    ds_read_b64_tr_b16 v[214:215], v231 offset:4096
    v_mfma_f32_32x32x16_bf16 v[48:63], v[216:219], v[92:95], v[48:63]
    s_add_u32 m0, s75, 8192
    s_nop 0
    s_waitcnt vmcnt(6)
    buffer_load_dwordx4 v2, s[28:31], s76 offen lds
    s_add_u32 s76, s76, 7168
    s_add_u32 m0, s75, 9216
    s_nop 0
    s_waitcnt vmcnt(6)
    buffer_load_dwordx4 v2, s[28:31], s76 offen lds
    s_add_u32 s76, s76, 7168
    v_mfma_f32_32x32x16_bf16 v[64:79], v[220:223], v[92:95], v[64:79]
    s_add_u32 m0, s75, 10240
    s_nop 0
    s_waitcnt vmcnt(6)
    buffer_load_dwordx4 v2, s[28:31], s76 offen lds
    s_add_u32 s76, s76, 7168
    s_add_u32 m0, s75, 11264
    s_nop 0
    s_waitcnt vmcnt(6)
    buffer_load_dwordx4 v2, s[28:31], s76 offen lds
    s_add_u32 s76, s76, 7168
    s_waitcnt vmcnt(6)
    buffer_load_dwordx4 v[88:91], v1, s[12:15], s77 offen offset:1024 sc1
    s_waitcnt vmcnt(6)
    buffer_load_dwordx4 v[92:95], v1, s[12:15], s78 offen offset:1024 sc1
    s_waitcnt vmcnt(26) lgkmcnt(8)
    v_mfma_f32_32x32x16_bf16 v[16:31], v[234:237], v[96:99], v[16:31]
    ds_read_b64_tr_b16 v[216:217], v230 offset:3072
    ds_read_b64_tr_b16 v[218:219], v230 offset:5120
    v_mfma_f32_32x32x16_bf16 v[32:47], v[238:241], v[96:99], v[32:47]
    ds_read_b64_tr_b16 v[220:221], v231 offset:3072
    ds_read_b64_tr_b16 v[222:223], v231 offset:5120
    v_mfma_f32_32x32x16_bf16 v[48:63], v[234:237], v[100:103], v[48:63]
    v_mfma_f32_32x32x16_bf16 v[64:79], v[238:241], v[100:103], v[64:79]
    s_waitcnt vmcnt(6)
    buffer_load_dwordx4 v[96:99], v1, s[12:15], s77 offen offset:2048 sc1
    s_waitcnt vmcnt(6)
    buffer_load_dwordx4 v[100:103], v1, s[12:15], s78 offen offset:2048 sc1
    s_waitcnt vmcnt(26) lgkmcnt(8)
    v_mfma_f32_32x32x16_bf16 v[16:31], v[242:245], v[104:107], v[16:31]
    ds_read_b64_tr_b16 v[234:235], v232 offset:6144
    ds_read_b64_tr_b16 v[236:237], v232 offset:6656
    v_mfma_f32_32x32x16_bf16 v[32:47], v[246:249], v[104:107], v[32:47]
    ds_read_b64_tr_b16 v[238:239], v233 offset:6144
    ds_read_b64_tr_b16 v[240:241], v233 offset:6656
    v_mfma_f32_32x32x16_bf16 v[48:63], v[242:245], v[108:111], v[48:63]
    s_add_u32 m0, s75, 12288
    s_nop 0
    s_waitcnt vmcnt(6)
    buffer_load_dwordx4 v2, s[28:31], s76 offen lds
    s_add_u32 s76, s76, 7168
    s_add_u32 m0, s75, 13312
    s_nop 0
    s_waitcnt vmcnt(6)
    buffer_load_dwordx4 v2, s[28:31], s76 offen lds
    s_add_u32 s76, s76, 7168
    v_mfma_f32_32x32x16_bf16 v[64:79], v[246:249], v[108:111], v[64:79]
    s_add_u32 m0, s3, 0
    s_nop 0
    s_waitcnt vmcnt(6)
    buffer_load_dwordx4 v2, s[28:31], s76 offen lds
    s_add_u32 s76, s76, 7168
    s_add_u32 m0, s3, 1024
    s_nop 0
    s_waitcnt vmcnt(6)
    buffer_load_dwordx4 v2, s[28:31], s76 offen lds
    s_add_u32 s76, s76, 7168
    s_waitcnt vmcnt(6)
    buffer_load_dwordx4 v[104:107], v1, s[12:15], s77 offen offset:3072 sc1
    s_waitcnt vmcnt(6)
    buffer_load_dwordx4 v[108:111], v1, s[12:15], s78 offen offset:3072 sc1
    s_add_u32 s77, s77, 4096
    s_add_u32 s78, s78, 4096
    s_waitcnt vmcnt(30) lgkmcnt(8)
    v_mfma_f32_32x32x16_bf16 v[16:31], v[208:211], v[112:115], v[16:31]
    ds_read_b64_tr_b16 v[242:243], v4 offset:0
    ds_read_b64_tr_b16 v[244:245], v4 offset:2048
    v_mfma_f32_32x32x16_bf16 v[32:47], v[212:215], v[112:115], v[32:47]
    ds_read_b64_tr_b16 v[246:247], v5 offset:0
    ds_read_b64_tr_b16 v[248:249], v5 offset:2048
    v_mfma_f32_32x32x16_bf16 v[48:63], v[208:211], v[116:119], v[48:63]
    v_mfma_f32_32x32x16_bf16 v[64:79], v[212:215], v[116:119], v[64:79]
    s_waitcnt vmcnt(6)
    buffer_load_dwordx4 v[112:115], v1, s[12:15], s77 offen offset:0 sc1
    s_waitcnt vmcnt(6)
    buffer_load_dwordx4 v[116:119], v1, s[12:15], s78 offen offset:0 sc1
    s_waitcnt vmcnt(30) lgkmcnt(8)
    v_mfma_f32_32x32x16_bf16 v[16:31], v[216:219], v[120:123], v[16:31]
    ds_read_b64_tr_b16 v[208:209], v4 offset:1024
    ds_read_b64_tr_b16 v[210:211], v4 offset:3072
    v_mfma_f32_32x32x16_bf16 v[32:47], v[220:223], v[120:123], v[32:47]
    ds_read_b64_tr_b16 v[212:213], v5 offset:1024
    ds_read_b64_tr_b16 v[214:215], v5 offset:3072
    v_mfma_f32_32x32x16_bf16 v[48:63], v[216:219], v[124:127], v[48:63]
    s_add_u32 m0, s3, 2048
    s_nop 0
    s_waitcnt vmcnt(6)
    buffer_load_dwordx4 v2, s[28:31], s76 offen lds
    s_add_u32 s76, s76, 7168
    s_add_u32 m0, s3, 3072
    s_nop 0
    s_waitcnt vmcnt(6)
    buffer_load_dwordx4 v2, s[28:31], s76 offen lds
    s_add_u32 s76, s76, 7168
    v_mfma_f32_32x32x16_bf16 v[64:79], v[220:223], v[124:127], v[64:79]
    s_add_u32 m0, s3, 4096
    s_nop 0
    s_waitcnt vmcnt(6)
    buffer_load_dwordx4 v2, s[28:31], s76 offen lds
    s_add_u32 s76, s76, 7168
    s_add_u32 m0, s3, 5120
    s_nop 0
    s_waitcnt vmcnt(6)
    buffer_load_dwordx4 v2, s[28:31], s76 offen lds
    s_add_u32 s76, s76, 7168
    s_waitcnt vmcnt(6)
    buffer_load_dwordx4 v[120:123], v1, s[12:15], s77 offen offset:1024 sc1
    s_waitcnt vmcnt(6)
    buffer_load_dwordx4 v[124:127], v1, s[12:15], s78 offen offset:1024 sc1
    s_waitcnt vmcnt(34) lgkmcnt(8)
    v_mfma_f32_32x32x16_bf16 v[16:31], v[234:237], v[128:131], v[16:31]
    ds_read_b64_tr_b16 v[216:217], v4 offset:4096
    ds_read_b64_tr_b16 v[218:219], v4 offset:6144
    v_mfma_f32_32x32x16_bf16 v[32:47], v[238:241], v[128:131], v[32:47]
    ds_read_b64_tr_b16 v[220:221], v5 offset:4096
    ds_read_b64_tr_b16 v[222:223], v5 offset:6144
    v_mfma_f32_32x32x16_bf16 v[48:63], v[234:237], v[132:135], v[48:63]
    s_add_u32 m0, s3, 6144
    s_nop 0
    s_waitcnt vmcnt(6)
    buffer_load_dwordx4 v2, s[28:31], s76 offen lds
    s_add_u32 s76, s76, 7168
    s_add_u32 m0, s3, 7168
    s_nop 0
    s_waitcnt vmcnt(6)
    buffer_load_dwordx4 v2, s[28:31], s76 offen lds
    s_add_u32 s76, s76, 7168
    v_mfma_f32_32x32x16_bf16 v[64:79], v[238:241], v[132:135], v[64:79]
    s_waitcnt vmcnt(6)
    buffer_load_dwordx4 v[128:131], v1, s[12:15], s77 offen offset:2048 sc1
    s_waitcnt vmcnt(6)
    buffer_load_dwordx4 v[132:135], v1, s[12:15], s78 offen offset:2048 sc1
    s_waitcnt vmcnt(36) lgkmcnt(8)
    v_mfma_f32_32x32x16_bf16 v[16:31], v[242:245], v[136:139], v[16:31]
    ds_read_b64_tr_b16 v[234:235], v4 offset:5120
    ds_read_b64_tr_b16 v[236:237], v4 offset:7168
    v_mfma_f32_32x32x16_bf16 v[32:47], v[246:249], v[136:139], v[32:47]
    ds_read_b64_tr_b16 v[238:239], v5 offset:5120
    ds_read_b64_tr_b16 v[240:241], v5 offset:7168
    v_mfma_f32_32x32x16_bf16 v[48:63], v[242:245], v[140:143], v[48:63]
    v_mfma_f32_32x32x16_bf16 v[64:79], v[246:249], v[140:143], v[64:79]
    s_waitcnt vmcnt(6)
    buffer_load_dwordx4 v[136:139], v1, s[12:15], s77 offen offset:3072 sc1
    s_waitcnt vmcnt(6)
    buffer_load_dwordx4 v[140:143], v1, s[12:15], s78 offen offset:3072 sc1
    s_add_u32 s77, s77, 4096
    s_add_u32 s78, s78, 4096
    s_waitcnt vmcnt(24) lgkmcnt(8)
    v_mfma_f32_32x32x16_bf16 v[16:31], v[208:211], v[144:147], v[16:31]
    ds_read_b64_tr_b16 v[242:243], v4 offset:8192
    ds_read_b64_tr_b16 v[244:245], v4 offset:10240
    v_mfma_f32_32x32x16_bf16 v[32:47], v[212:215], v[144:147], v[32:47]
    ds_read_b64_tr_b16 v[246:247], v5 offset:8192
    ds_read_b64_tr_b16 v[248:249], v5 offset:10240
    v_mfma_f32_32x32x16_bf16 v[48:63], v[208:211], v[148:151], v[48:63]
    s_add_u32 m0, s75, 0
    s_nop 0
    s_waitcnt vmcnt(6)
    buffer_load_dwordx4 v2, s[28:31], s76 offen lds
    s_add_u32 s76, s76, 7168
    s_add_u32 m0, s75, 1024
    s_nop 0
    s_waitcnt vmcnt(6)
    buffer_load_dwordx4 v2, s[28:31], s76 offen lds
    s_add_u32 s76, s76, 7168
    v_mfma_f32_32x32x16_bf16 v[64:79], v[212:215], v[148:151], v[64:79]
    s_add_u32 m0, s75, 2048
    s_nop 0
    s_waitcnt vmcnt(6)
    buffer_load_dwordx4 v2, s[28:31], s76 offen lds
    s_add_u32 s76, s76, 7168
    s_add_u32 m0, s75, 3072
    s_nop 0
    s_waitcnt vmcnt(6)
    buffer_load_dwordx4 v2, s[28:31], s76 offen lds
    s_add_u32 s76, s76, 7168
    s_waitcnt vmcnt(6)
    buffer_load_dwordx4 v[144:147], v1, s[12:15], s77 offen offset:0 sc1
    s_waitcnt vmcnt(6)
    buffer_load_dwordx4 v[148:151], v1, s[12:15], s78 offen offset:0 sc1
    s_waitcnt vmcnt(30) lgkmcnt(8)
    v_mfma_f32_32x32x16_bf16 v[16:31], v[216:219], v[152:155], v[16:31]
    ds_read_b64_tr_b16 v[208:209], v4 offset:9216
    ds_read_b64_tr_b16 v[210:211], v4 offset:11264
    v_mfma_f32_32x32x16_bf16 v[32:47], v[220:223], v[152:155], v[32:47]
    ds_read_b64_tr_b16 v[212:213], v5 offset:9216
    ds_read_b64_tr_b16 v[214:215], v5 offset:11264
    v_mfma_f32_32x32x16_bf16 v[48:63], v[216:219], v[156:159], v[48:63]
    v_mfma_f32_32x32x16_bf16 v[64:79], v[220:223], v[156:159], v[64:79]
    s_waitcnt vmcnt(6)
    buffer_load_dwordx4 v[152:155], v1, s[12:15], s77 offen offset:1024 sc1
    s_waitcnt vmcnt(6)
    buffer_load_dwordx4 v[156:159], v1, s[12:15], s78 offen offset:1024 sc1
    s_waitcnt vmcnt(26) lgkmcnt(8)
    v_mfma_f32_32x32x16_bf16 v[16:31], v[234:237], v[160:163], v[16:31]
    ds_read_b64_tr_b16 v[216:217], v6 offset:12288
    ds_read_b64_tr_b16 v[218:219], v6 offset:12800
    v_mfma_f32_32x32x16_bf16 v[32:47], v[238:241], v[160:163], v[32:47]
    ds_read_b64_tr_b16 v[220:221], v7 offset:12288
    ds_read_b64_tr_b16 v[222:223], v7 offset:12800
    v_mfma_f32_32x32x16_bf16 v[48:63], v[234:237], v[164:167], v[48:63]
    s_add_u32 m0, s75, 4096
    s_nop 0
    s_waitcnt vmcnt(6)
    buffer_load_dwordx4 v2, s[28:31], s76 offen lds
    s_add_u32 s76, s76, 7168
    s_add_u32 m0, s75, 5120
    s_nop 0
    s_waitcnt vmcnt(6)
    buffer_load_dwordx4 v2, s[28:31], s76 offen lds
    s_add_u32 s76, s76, 7168
    v_mfma_f32_32x32x16_bf16 v[64:79], v[238:241], v[164:167], v[64:79]
    s_add_u32 m0, s75, 6144
    s_nop 0
    s_waitcnt vmcnt(6)
    buffer_load_dwordx4 v2, s[28:31], s76 offen lds
    s_add_u32 s76, s76, 7168
    s_add_u32 m0, s75, 7168
    s_nop 0
    s_waitcnt vmcnt(6)
    buffer_load_dwordx4 v2, s[28:31], s76 offen lds
    s_add_u32 s76, s76, 7168
    s_waitcnt vmcnt(6)
    buffer_load_dwordx4 v[160:163], v1, s[12:15], s77 offen offset:2048 sc1
    s_waitcnt vmcnt(6)
    buffer_load_dwordx4 v[164:167], v1, s[12:15], s78 offen offset:2048 sc1
    s_waitcnt vmcnt(24) lgkmcnt(8)
    v_mfma_f32_32x32x16_bf16 v[16:31], v[242:245], v[168:171], v[16:31]
    ds_read_b64_tr_b16 v[234:235], v230 offset:0
    ds_read_b64_tr_b16 v[236:237], v230 offset:2048
    v_mfma_f32_32x32x16_bf16 v[32:47], v[246:249], v[168:171], v[32:47]
    ds_read_b64_tr_b16 v[238:239], v231 offset:0
    ds_read_b64_tr_b16 v[240:241], v231 offset:2048
    v_mfma_f32_32x32x16_bf16 v[48:63], v[242:245], v[172:175], v[48:63]
    v_mfma_f32_32x32x16_bf16 v[64:79], v[246:249], v[172:175], v[64:79]
    s_waitcnt vmcnt(6)
    buffer_load_dwordx4 v[168:171], v1, s[12:15], s77 offen offset:3072 sc1
    s_waitcnt vmcnt(6)
    buffer_load_dwordx4 v[172:175], v1, s[12:15], s78 offen offset:3072 sc1
    s_add_u32 s77, s77, 4096
    s_add_u32 s78, s78, 4096
    s_waitcnt vmcnt(26) lgkmcnt(8)
    v_mfma_f32_32x32x16_bf16 v[16:31], v[208:211], v[80:83], v[16:31]
    ds_read_b64_tr_b16 v[242:243], v230 offset:1024
    ds_read_b64_tr_b16 v[244:245], v230 offset:3072
    v_mfma_f32_32x32x16_bf16 v[32:47], v[212:215], v[80:83], v[32:47]
    ds_read_b64_tr_b16 v[246:247], v231 offset:1024
    ds_read_b64_tr_b16 v[248:249], v231 offset:3072
    v_mfma_f32_32x32x16_bf16 v[48:63], v[208:211], v[84:87], v[48:63]
    s_add_u32 m0, s75, 8192
    s_nop 0
    s_waitcnt vmcnt(6)
    buffer_load_dwordx4 v2, s[28:31], s76 offen lds
    s_add_u32 s76, s76, 7168
    s_add_u32 m0, s75, 9216
    s_nop 0
    s_waitcnt vmcnt(6)
    buffer_load_dwordx4 v2, s[28:31], s76 offen lds
    s_add_u32 s76, s76, 7168
    v_mfma_f32_32x32x16_bf16 v[64:79], v[212:215], v[84:87], v[64:79]
    s_add_u32 m0, s75, 10240
    s_nop 0
    s_waitcnt vmcnt(6)
    buffer_load_dwordx4 v2, s[28:31], s76 offen lds
    s_add_u32 s76, s76, 7168
    s_add_u32 m0, s75, 11264
    s_nop 0
    s_waitcnt vmcnt(6)
    buffer_load_dwordx4 v2, s[28:31], s76 offen lds
    s_add_u32 s76, s76, 7168
    s_waitcnt vmcnt(6)
    buffer_load_dwordx4 v[80:83], v1, s[12:15], s77 offen offset:0 sc1
    s_waitcnt vmcnt(6)
    buffer_load_dwordx4 v[84:87], v1, s[12:15], s78 offen offset:0 sc1
    s_waitcnt vmcnt(26) lgkmcnt(8)
    v_mfma_f32_32x32x16_bf16 v[16:31], v[216:219], v[88:91], v[16:31]
    ds_read_b64_tr_b16 v[208:209], v230 offset:4096
    ds_read_b64_tr_b16 v[210:211], v230 offset:6144
    v_mfma_f32_32x32x16_bf16 v[32:47], v[220:223], v[88:91], v[32:47]
    ds_read_b64_tr_b16 v[212:213], v231 offset:4096
    ds_read_b64_tr_b16 v[214:215], v231 offset:6144
    v_mfma_f32_32x32x16_bf16 v[48:63], v[216:219], v[92:95], v[48:63]
    s_add_u32 m0, s75, 12288
    s_nop 0
    s_waitcnt vmcnt(6)
    buffer_load_dwordx4 v2, s[28:31], s76 offen lds
    s_add_u32 s76, s76, 7168
    s_add_u32 m0, s75, 13312
    s_nop 0
    s_waitcnt vmcnt(6)
    buffer_load_dwordx4 v2, s[28:31], s76 offen lds
    s_add_u32 s76, s76, 7168
    v_mfma_f32_32x32x16_bf16 v[64:79], v[220:223], v[92:95], v[64:79]
    s_waitcnt vmcnt(6)
    buffer_load_dwordx4 v[88:91], v1, s[12:15], s77 offen offset:1024 sc1
    s_waitcnt vmcnt(6)
    buffer_load_dwordx4 v[92:95], v1, s[12:15], s78 offen offset:1024 sc1
    s_waitcnt vmcnt(30) lgkmcnt(8)
    v_mfma_f32_32x32x16_bf16 v[16:31], v[234:237], v[96:99], v[16:31]
    ds_read_b64_tr_b16 v[216:217], v230 offset:5120
    ds_read_b64_tr_b16 v[218:219], v230 offset:7168
    v_mfma_f32_32x32x16_bf16 v[32:47], v[238:241], v[96:99], v[32:47]
    ds_read_b64_tr_b16 v[220:221], v231 offset:5120
    ds_read_b64_tr_b16 v[222:223], v231 offset:7168
    v_mfma_f32_32x32x16_bf16 v[48:63], v[234:237], v[100:103], v[48:63]
    v_mfma_f32_32x32x16_bf16 v[64:79], v[238:241], v[100:103], v[64:79]
    s_waitcnt vmcnt(6)
    buffer_load_dwordx4 v[96:99], v1, s[12:15], s77 offen offset:2048 sc1
    s_waitcnt vmcnt(6)
    buffer_load_dwordx4 v[100:103], v1, s[12:15], s78 offen offset:2048 sc1
    s_waitcnt vmcnt(24) lgkmcnt(8)
    v_mfma_f32_32x32x16_bf16 v[16:31], v[242:245], v[104:107], v[16:31]
    ds_read_b64_tr_b16 v[234:235], v4 offset:0
    ds_read_b64_tr_b16 v[236:237], v4 offset:2048
    v_mfma_f32_32x32x16_bf16 v[32:47], v[246:249], v[104:107], v[32:47]
    ds_read_b64_tr_b16 v[238:239], v5 offset:0
    ds_read_b64_tr_b16 v[240:241], v5 offset:2048
    v_mfma_f32_32x32x16_bf16 v[48:63], v[242:245], v[108:111], v[48:63]
    s_add_u32 m0, s3, 0
    s_nop 0
    s_waitcnt vmcnt(6)
    buffer_load_dwordx4 v2, s[28:31], s76 offen lds
    s_add_u32 s76, s76, 7168
    s_add_u32 m0, s3, 1024
    s_nop 0
    s_waitcnt vmcnt(6)
    buffer_load_dwordx4 v2, s[28:31], s76 offen lds
    s_add_u32 s76, s76, 7168
    v_mfma_f32_32x32x16_bf16 v[64:79], v[246:249], v[108:111], v[64:79]
    s_add_u32 m0, s3, 2048
    s_nop 0
    s_waitcnt vmcnt(6)
    buffer_load_dwordx4 v2, s[28:31], s76 offen lds
    s_add_u32 s76, s76, 7168
    s_add_u32 m0, s3, 3072
    s_nop 0
    s_waitcnt vmcnt(6)
    buffer_load_dwordx4 v2, s[28:31], s76 offen lds
    s_add_u32 s76, s76, 7168
    s_waitcnt vmcnt(6)
    buffer_load_dwordx4 v[104:107], v1, s[12:15], s77 offen offset:3072 sc1
    s_waitcnt vmcnt(6)
    buffer_load_dwordx4 v[108:111], v1, s[12:15], s78 offen offset:3072 sc1
    s_add_u32 s77, s77, 4096
    s_add_u32 s78, s78, 4096
    s_barrier
    s_setprio 2
    s_waitcnt vmcnt(30) lgkmcnt(8)
    v_mfma_f32_32x32x16_bf16 v[16:31], v[208:211], v[112:115], v[16:31]
    ds_read_b64_tr_b16 v[242:243], v4 offset:1024
    ds_read_b64_tr_b16 v[244:245], v4 offset:3072
    s_add_u32 s66, s64, 4096
    s_add_u32 s67, s65, 4096
    v_mfma_f32_32x32x16_bf16 v[32:47], v[212:215], v[112:115], v[32:47]
    ds_read_b64_tr_b16 v[246:247], v5 offset:1024
    ds_read_b64_tr_b16 v[248:249], v5 offset:3072
    v_sub_f32 v14, 1.0, v14
    v_sub_f32 v15, 1.0, v15
    v_mfma_f32_32x32x16_bf16 v[48:63], v[208:211], v[116:119], v[48:63]
    s_and_b32 s6, s73, 0xbfff0000
    s_mov_b32 s5, 0xffff
    v_mfma_f32_32x32x16_bf16 v[64:79], v[212:215], v[116:119], v[64:79]
    s_mov_b32 s7, 0x20000
    s_xor_b32 s79, s68, 1
    s_waitcnt vmcnt(24) lgkmcnt(8)
    v_mfma_f32_32x32x16_bf16 v[16:31], v[216:219], v[120:123], v[16:31]
    ds_read_b64_tr_b16 v[208:209], v6 offset:4096
    ds_read_b64_tr_b16 v[210:211], v6 offset:4608
    s_mul_i32 s79, s79, 28672
    v_add_u32 v8, s79, v1
    v_mfma_f32_32x32x16_bf16 v[32:47], v[220:223], v[120:123], v[32:47]
    ds_read_b64_tr_b16 v[212:213], v7 offset:4096
    ds_read_b64_tr_b16 v[214:215], v7 offset:4608
    s_xor_b32 s79, s68, 2
    s_mul_i32 s79, s79, 28672
    v_mfma_f32_32x32x16_bf16 v[48:63], v[216:219], v[124:127], v[48:63]
    s_add_u32 m0, s3, 4096
    s_nop 0
    buffer_load_dwordx4 v2, s[28:31], s76 offen lds
    s_add_u32 s76, s76, 7168
    s_add_u32 m0, s3, 5120
    s_nop 0
    buffer_load_dwordx4 v2, s[28:31], s76 offen lds
    s_add_u32 s76, s76, 7168
    v_add_u32 v9, s79, v1
    s_xor_b32 s79, s68, 3
    v_mfma_f32_32x32x16_bf16 v[64:79], v[220:223], v[124:127], v[64:79]
    s_add_u32 m0, s3, 6144
    s_add_u32 s4, s80, 0
    buffer_load_dwordx4 v3, s[32:35], s4 offen lds
    s_add_u32 m0, s3, 7168
    s_add_u32 s4, s80, 12544
    buffer_load_dwordx4 v3, s[32:35], s4 offen lds
    s_mul_i32 s79, s79, 28672
    v_add_u32 v10, s79, v1
    s_waitcnt vmcnt(20) lgkmcnt(8)
    v_mfma_f32_32x32x16_bf16 v[16:31], v[234:237], v[128:131], v[16:31]
    ds_read_b64_tr_b16 v[216:217], v4 offset:6144
    ds_read_b64_tr_b16 v[218:219], v4 offset:8192
    s_mul_i32 s74, s71, 28672
    s_lshl_b32 s79, s72, 7
    v_mfma_f32_32x32x16_bf16 v[32:47], v[238:241], v[128:131], v[32:47]
    ds_read_b64_tr_b16 v[220:221], v5 offset:6144
    ds_read_b64_tr_b16 v[222:223], v5 offset:8192
    s_add_u32 s74, s74, s79
    s_and_b32 s79, s68, 1
    v_mfma_f32_32x32x16_bf16 v[48:63], v[234:237], v[132:135], v[48:63]
    s_lshl_b32 s79, s79, 6
    s_add_u32 s74, s74, s79
    v_mfma_f32_32x32x16_bf16 v[64:79], v[238:241], v[132:135], v[64:79]
    s_waitcnt vmcnt(20) lgkmcnt(8)
    v_mfma_f32_32x32x16_bf16 v[16:31], v[242:245], v[136:139], v[16:31]
    ds_read_b64_tr_b16 v[234:235], v4 offset:7168
    ds_read_b64_tr_b16 v[236:237], v4 offset:9216
    v_mfma_f32_32x32x16_bf16 v[32:47], v[246:249], v[136:139], v[32:47]
    ds_read_b64_tr_b16 v[238:239], v5 offset:7168
    ds_read_b64_tr_b16 v[240:241], v5 offset:9216
    v_mfma_f32_32x32x16_bf16 v[48:63], v[242:245], v[140:143], v[48:63]
    s_add_u32 m0, s75, 0
    s_add_u32 s4, s80, 6272
    buffer_load_dwordx4 v3, s[32:35], s4 offen lds
    s_add_u32 m0, s75, 1024
    s_add_u32 s4, s80, 18816
    buffer_load_dwordx4 v3, s[32:35], s4 offen lds
    v_mfma_f32_32x32x16_bf16 v[64:79], v[246:249], v[140:143], v[64:79]
    s_add_u32 m0, s75, 2048
    s_add_u32 s4, s80, 25088
    buffer_load_dwordx4 v3, s[32:35], s4 offen lds
    s_add_u32 m0, s75, 3072
    s_add_u32 s4, s80, 37632
    buffer_load_dwordx4 v3, s[32:35], s4 offen lds
    s_waitcnt vmcnt(18) lgkmcnt(8)
    v_mfma_f32_32x32x16_bf16 v[16:31], v[208:211], v[144:147], v[16:31]
    ds_read_b64_tr_b16 v[242:243], v4 offset:10240
    ds_read_b64_tr_b16 v[244:245], v4 offset:12288
    v_mfma_f32_32x32x16_bf16 v[32:47], v[212:215], v[144:147], v[32:47]
    ds_read_b64_tr_b16 v[246:247], v5 offset:10240
    ds_read_b64_tr_b16 v[248:249], v5 offset:12288
    v_mfma_f32_32x32x16_bf16 v[48:63], v[208:211], v[148:151], v[48:63]
    s_add_u32 m0, s75, 4096
    s_add_u32 s4, s80, 31360
    buffer_load_dwordx4 v3, s[32:35], s4 offen lds
    s_add_u32 m0, s75, 5120
    s_add_u32 s4, s80, 43904
    buffer_load_dwordx4 v3, s[32:35], s4 offen lds
    v_mfma_f32_32x32x16_bf16 v[64:79], v[212:215], v[148:151], v[64:79]
    s_waitcnt vmcnt(20) lgkmcnt(8)
    v_mfma_f32_32x32x16_bf16 v[16:31], v[216:219], v[152:155], v[16:31]
    ds_read_b64_tr_b16 v[208:209], v4 offset:11264
    ds_read_b64_tr_b16 v[210:211], v4 offset:13312
    v_mfma_f32_32x32x16_bf16 v[32:47], v[220:223], v[152:155], v[32:47]
    ds_read_b64_tr_b16 v[212:213], v5 offset:11264
    ds_read_b64_tr_b16 v[214:215], v5 offset:13312
    v_mfma_f32_32x32x16_bf16 v[48:63], v[216:219], v[156:159], v[48:63]
    v_mfma_f32_32x32x16_bf16 v[64:79], v[220:223], v[156:159], v[64:79]
    s_waitcnt vmcnt(12) lgkmcnt(8)
    v_mfma_f32_32x32x16_bf16 v[16:31], v[234:237], v[160:163], v[16:31]
    ds_read_b64_tr_b16 v[216:217], v230 offset:0
    ds_read_b64_tr_b16 v[218:219], v230 offset:2048
    v_mfma_f32_32x32x16_bf16 v[32:47], v[238:241], v[160:163], v[32:47]
    ds_read_b64_tr_b16 v[220:221], v231 offset:0
    ds_read_b64_tr_b16 v[222:223], v231 offset:2048
    v_mfma_f32_32x32x16_bf16 v[48:63], v[234:237], v[164:167], v[48:63]
    v_mfma_f32_32x32x16_bf16 v[64:79], v[238:241], v[164:167], v[64:79]
    s_waitcnt vmcnt(12) lgkmcnt(8)
    v_mfma_f32_32x32x16_bf16 v[16:31], v[242:245], v[168:171], v[16:31]
    ds_read_b64_tr_b16 v[234:235], v230 offset:1024
    ds_read_b64_tr_b16 v[236:237], v230 offset:3072
    v_mfma_f32_32x32x16_bf16 v[32:47], v[246:249], v[168:171], v[32:47]
    ds_read_b64_tr_b16 v[238:239], v231 offset:1024
    ds_read_b64_tr_b16 v[240:241], v231 offset:3072
    v_mfma_f32_32x32x16_bf16 v[48:63], v[242:245], v[172:175], v[48:63]
    v_mfma_f32_32x32x16_bf16 v[64:79], v[246:249], v[172:175], v[64:79]
    s_waitcnt vmcnt(8) lgkmcnt(8)
    v_mfma_f32_32x32x16_bf16 v[16:31], v[208:211], v[80:83], v[16:31]
    ds_read_b64_tr_b16 v[242:243], v232 offset:4096
    ds_read_b64_tr_b16 v[244:245], v232 offset:4608
    v_mfma_f32_32x32x16_bf16 v[32:47], v[212:215], v[80:83], v[32:47]
    ds_read_b64_tr_b16 v[246:247], v233 offset:4096
    ds_read_b64_tr_b16 v[248:249], v233 offset:4608
    v_mfma_f32_32x32x16_bf16 v[48:63], v[208:211], v[84:87], v[48:63]
    v_mfma_f32_32x32x16_bf16 v[64:79], v[212:215], v[84:87], v[64:79]
    s_waitcnt vmcnt(18) lgkmcnt(8)
    v_mfma_f32_32x32x16_bf16 v[16:31], v[216:219], v[88:91], v[16:31]
    v_mfma_f32_32x32x16_bf16 v[32:47], v[220:223], v[88:91], v[32:47]
    v_mfma_f32_32x32x16_bf16 v[48:63], v[216:219], v[92:95], v[48:63]
    v_mfma_f32_32x32x16_bf16 v[64:79], v[220:223], v[92:95], v[64:79]
    s_waitcnt vmcnt(4) lgkmcnt(4)
    v_mfma_f32_32x32x16_bf16 v[16:31], v[234:237], v[96:99], v[16:31]
    ds_read_b64_tr_b16 v[144:145], v232 offset:6144
    ds_read_b64_tr_b16 v[146:147], v232 offset:6656
    v_mfma_f32_32x32x16_bf16 v[32:47], v[238:241], v[96:99], v[32:47]
    ds_read_b64_tr_b16 v[148:149], v233 offset:6144
    ds_read_b64_tr_b16 v[150:151], v233 offset:6656
    v_mfma_f32_32x32x16_bf16 v[48:63], v[234:237], v[100:103], v[48:63]
    ds_read_b64_tr_b16 v[152:153], v6 offset:0
    ds_read_b64_tr_b16 v[154:155], v6 offset:512
    v_mfma_f32_32x32x16_bf16 v[64:79], v[238:241], v[100:103], v[64:79]
    ds_read_b64_tr_b16 v[156:157], v7 offset:0
    ds_read_b64_tr_b16 v[158:159], v7 offset:512
    s_waitcnt vmcnt(0) lgkmcnt(8)
    v_mfma_f32_32x32x16_bf16 v[16:31], v[242:245], v[104:107], v[16:31]
    ds_read_b64_tr_b16 v[160:161], v6 offset:2048
    ds_read_b64_tr_b16 v[162:163], v6 offset:2560
    v_mfma_f32_32x32x16_bf16 v[32:47], v[246:249], v[104:107], v[32:47]
    ds_read_b64_tr_b16 v[164:165], v7 offset:2048
    ds_read_b64_tr_b16 v[166:167], v7 offset:2560
    v_mfma_f32_32x32x16_bf16 v[48:63], v[242:245], v[108:111], v[48:63]
    ds_read_b64_tr_b16 v[168:169], v6 offset:4096
    ds_read_b64_tr_b16 v[170:171], v6 offset:4608
    v_mfma_f32_32x32x16_bf16 v[64:79], v[246:249], v[108:111], v[64:79]
    s_waitcnt lgkmcnt(12)
    ds_read_b64_tr_b16 v[172:173], v7 offset:4096
    ds_read_b64_tr_b16 v[174:175], v7 offset:4608
    buffer_load_dwordx4 v[112:115], v1, s[12:15], s66 offen offset:0 sc1
    buffer_load_dwordx4 v[116:119], v1, s[12:15], s67 offen offset:0 sc1
    buffer_load_dwordx4 v[120:123], v1, s[12:15], s66 offen offset:1024 sc1
    buffer_load_dwordx4 v[124:127], v1, s[12:15], s67 offen offset:1024 sc1
    s_nop 3
    v_mul_f32 v16, v14, v16
    v_mul_f32 v17, v14, v17
    v_mul_f32 v18, v14, v18
    v_mul_f32 v19, v14, v19
    buffer_load_dwordx4 v[128:131], v1, s[12:15], s66 offen offset:2048 sc1
    v_mul_f32 v20, v14, v20
    v_mul_f32 v21, v14, v21
    v_mul_f32 v22, v14, v22
    v_mul_f32 v23, v14, v23
    buffer_load_dwordx4 v[132:135], v1, s[12:15], s67 offen offset:2048 sc1
    v_mul_f32 v24, v14, v24
    v_mul_f32 v25, v14, v25
    v_mul_f32 v26, v14, v26
    v_mul_f32 v27, v14, v27
    buffer_load_dwordx4 v[136:139], v1, s[12:15], s66 offen offset:3072 sc1
    v_mul_f32 v28, v14, v28
    v_mul_f32 v29, v14, v29
    v_mul_f32 v30, v14, v30
    v_mul_f32 v31, v14, v31
    buffer_load_dwordx4 v[140:143], v1, s[12:15], s67 offen offset:3072 sc1
    v_mul_f32 v32, v14, v32
    v_mul_f32 v33, v14, v33
    v_mul_f32 v34, v14, v34
    v_mul_f32 v35, v14, v35
    v_mul_f32 v36, v14, v36
    v_mul_f32 v37, v14, v37
    v_mul_f32 v38, v14, v38
    v_mul_f32 v39, v14, v39
    v_mul_f32 v40, v14, v40
    v_mul_f32 v41, v14, v41
    v_mul_f32 v42, v14, v42
    v_mul_f32 v43, v14, v43
    v_mul_f32 v44, v14, v44
    v_mul_f32 v45, v14, v45
    v_mul_f32 v46, v14, v46
    v_mul_f32 v47, v14, v47
    v_mul_f32 v48, v15, v48
    v_mul_f32 v49, v15, v49
    v_mul_f32 v50, v15, v50
    v_mul_f32 v51, v15, v51
    v_mul_f32 v52, v15, v52
    v_mul_f32 v53, v15, v53
    v_mul_f32 v54, v15, v54
    v_mul_f32 v55, v15, v55
    v_mul_f32 v56, v15, v56
    v_mul_f32 v57, v15, v57
    v_mul_f32 v58, v15, v58
    v_mul_f32 v59, v15, v59
    v_mul_f32 v60, v15, v60
    v_mul_f32 v61, v15, v61
    v_mul_f32 v62, v15, v62
    v_mul_f32 v63, v15, v63
    v_mul_f32 v64, v15, v64
    v_mul_f32 v65, v15, v65
    v_mul_f32 v66, v15, v66
    v_mul_f32 v67, v15, v67
    v_mul_f32 v68, v15, v68
    v_mul_f32 v69, v15, v69
    v_mul_f32 v70, v15, v70
    v_mul_f32 v71, v15, v71
    v_mul_f32 v72, v15, v72
    v_mul_f32 v73, v15, v73
    v_mul_f32 v74, v15, v74
    v_mul_f32 v75, v15, v75
    v_mul_f32 v76, v15, v76
    v_mul_f32 v77, v15, v77
    v_mul_f32 v78, v15, v78
    v_mul_f32 v79, v15, v79
    v_not_b32 v87, s6
    v_not_b32 v95, s6
    v_not_b32 v103, s6
    v_not_b32 v111, s6
    v_add_u32 v2, s75, v1
    s_waitcnt lgkmcnt(0)
    s_waitcnt vmcnt(6)
    v_xor_b32 v12, s6, v115
    v_xor_b32 v13, s6, v119
    v_or_b32 v12, v12, v13
    v_cmp_lt_u32 vcc, s5, v12
    s_mov_b32 s4, 0
    s_cbranch_vccnz L_or
    v_mfma_f32_32x32x16_bf16 v[32:47], v[180:183], v[112:115], v[32:47]
    buffer_load_dwordx4 v[80:83], v1, s[12:15], s64 offen offset:0 sc1
    v_mfma_f32_32x32x16_bf16 v[48:63], v[176:179], v[116:119], v[48:63]
    buffer_load_dwordx4 v[84:87], v1, s[12:15], s65 offen offset:0 sc1
    v_mfma_f32_32x32x16_bf16 v[64:79], v[180:183], v[116:119], v[64:79]
    buffer_load_dwordx4 v[88:91], v1, s[12:15], s64 offen offset:1024 sc1
    s_waitcnt vmcnt(7)
    v_xor_b32 v12, s6, v123
    v_xor_b32 v13, s6, v127
    v_or_b32 v12, v12, v13
    v_cmp_lt_u32 vcc, s5, v12
    s_mov_b32 s4, 1
    s_cbranch_vccnz L_or
    v_mfma_f32_32x32x16_bf16 v[32:47], v[188:191], v[120:123], v[32:47]
    buffer_load_dwordx4 v[92:95], v1, s[12:15], s65 offen offset:1024 sc1
    v_mfma_f32_32x32x16_bf16 v[48:63], v[184:187], v[124:127], v[48:63]
    buffer_load_dwordx4 v[96:99], v1, s[12:15], s64 offen offset:2048 sc1
    v_mfma_f32_32x32x16_bf16 v[64:79], v[188:191], v[124:127], v[64:79]
    buffer_load_dwordx4 v[100:103], v1, s[12:15], s65 offen offset:2048 sc1
    s_waitcnt vmcnt(8)
    v_xor_b32 v12, s6, v131
    v_xor_b32 v13, s6, v135
    v_or_b32 v12, v12, v13
    v_cmp_lt_u32 vcc, s5, v12
    s_mov_b32 s4, 2
    s_cbranch_vccnz L_or
    v_mfma_f32_32x32x16_bf16 v[32:47], v[196:199], v[128:131], v[32:47]
    buffer_load_dwordx4 v[104:107], v1, s[12:15], s64 offen offset:3072 sc1
    v_mfma_f32_32x32x16_bf16 v[48:63], v[192:195], v[132:135], v[48:63]
    buffer_load_dwordx4 v[108:111], v1, s[12:15], s65 offen offset:3072 sc1
    v_mfma_f32_32x32x16_bf16 v[64:79], v[196:199], v[132:135], v[64:79]
    s_waitcnt vmcnt(8)
    v_xor_b32 v12, s6, v139
    v_xor_b32 v13, s6, v143
    v_or_b32 v12, v12, v13
    v_cmp_lt_u32 vcc, s5, v12
    s_mov_b32 s4, 3
    s_cbranch_vccnz L_or
    v_mfma_f32_32x32x16_bf16 v[32:47], v[204:207], v[136:139], v[32:47]
    v_mfma_f32_32x32x16_bf16 v[48:63], v[200:203], v[140:143], v[48:63]
    v_mfma_f32_32x32x16_bf16 v[64:79], v[204:207], v[140:143], v[64:79]
    s_waitcnt vmcnt(6)
    v_xor_b32 v12, s6, v83
    v_xor_b32 v13, s6, v87
    v_or_b32 v12, v12, v13
    v_cmp_lt_u32 vcc, s5, v12
    s_mov_b32 s4, 4
    s_cbranch_vccnz L_or
    v_mfma_f32_32x32x16_bf16 v[32:47], v[148:151], v[80:83], v[32:47]
    v_mfma_f32_32x32x16_bf16 v[48:63], v[144:147], v[84:87], v[48:63]
    v_mfma_f32_32x32x16_bf16 v[64:79], v[148:151], v[84:87], v[64:79]
    s_waitcnt vmcnt(4)
    v_xor_b32 v12, s6, v91
    v_xor_b32 v13, s6, v95
    v_or_b32 v12, v12, v13
    v_cmp_lt_u32 vcc, s5, v12
    s_mov_b32 s4, 5
    s_cbranch_vccnz L_or
    v_mfma_f32_32x32x16_bf16 v[32:47], v[156:159], v[88:91], v[32:47]
    v_mfma_f32_32x32x16_bf16 v[48:63], v[152:155], v[92:95], v[48:63]
    v_mfma_f32_32x32x16_bf16 v[64:79], v[156:159], v[92:95], v[64:79]
    s_waitcnt vmcnt(2)
    v_xor_b32 v12, s6, v99
    v_xor_b32 v13, s6, v103
    v_or_b32 v12, v12, v13
    v_cmp_lt_u32 vcc, s5, v12
    s_mov_b32 s4, 6
    s_cbranch_vccnz L_or
    v_mfma_f32_32x32x16_bf16 v[32:47], v[164:167], v[96:99], v[32:47]
    v_mfma_f32_32x32x16_bf16 v[48:63], v[160:163], v[100:103], v[48:63]
    v_mfma_f32_32x32x16_bf16 v[64:79], v[164:167], v[100:103], v[64:79]
    s_waitcnt vmcnt(0)
    v_xor_b32 v12, s6, v107
    v_xor_b32 v13, s6, v111
    v_or_b32 v12, v12, v13
    v_cmp_lt_u32 vcc, s5, v12
    s_mov_b32 s4, 7
    s_cbranch_vccnz L_or
    v_mfma_f32_32x32x16_bf16 v[32:47], v[172:175], v[104:107], v[32:47]
    v_mfma_f32_32x32x16_bf16 v[48:63], v[168:171], v[108:111], v[48:63]
    v_mfma_f32_32x32x16_bf16 v[64:79], v[172:175], v[108:111], v[64:79]
    s_branch L_od
L_or:
    s_waitcnt vmcnt(0)
    v_xor_b32 v12, s6, v115
    v_xor_b32 v13, s6, v119
    v_or_b32 v12, v12, v13
    v_cmp_lt_u32 vcc, s5, v12
    s_cmp_lg_u32 s4, 0
    s_cbranch_vccnz L_or0
    s_cbranch_scc1 L_on0
    v_mfma_f32_32x32x16_bf16 v[32:47], v[180:183], v[112:115], v[32:47]
    v_mfma_f32_32x32x16_bf16 v[48:63], v[176:179], v[116:119], v[48:63]
    v_mfma_f32_32x32x16_bf16 v[64:79], v[180:183], v[116:119], v[64:79]
    s_mov_b32 s4, 1
    s_branch L_on0
L_or0:
    buffer_load_dwordx4 v[112:115], v1, s[12:15], s66 offen offset:0 sc1
    buffer_load_dwordx4 v[116:119], v1, s[12:15], s67 offen offset:0 sc1
L_on0:
    v_xor_b32 v12, s6, v123
    v_xor_b32 v13, s6, v127
    v_or_b32 v12, v12, v13
    v_cmp_lt_u32 vcc, s5, v12
    s_cmp_lg_u32 s4, 1
    s_cbranch_vccnz L_or1
    s_cbranch_scc1 L_on1
    v_mfma_f32_32x32x16_bf16 v[32:47], v[188:191], v[120:123], v[32:47]
    v_mfma_f32_32x32x16_bf16 v[48:63], v[184:187], v[124:127], v[48:63]
    v_mfma_f32_32x32x16_bf16 v[64:79], v[188:191], v[124:127], v[64:79]
    s_mov_b32 s4, 2
    s_branch L_on1
L_or1:
    buffer_load_dwordx4 v[120:123], v1, s[12:15], s66 offen offset:1024 sc1
    buffer_load_dwordx4 v[124:127], v1, s[12:15], s67 offen offset:1024 sc1
L_on1:
    v_xor_b32 v12, s6, v131
    v_xor_b32 v13, s6, v135
    v_or_b32 v12, v12, v13
    v_cmp_lt_u32 vcc, s5, v12
    s_cmp_lg_u32 s4, 2
    s_cbranch_vccnz L_or2
    s_cbranch_scc1 L_on2
    v_mfma_f32_32x32x16_bf16 v[32:47], v[196:199], v[128:131], v[32:47]
    v_mfma_f32_32x32x16_bf16 v[48:63], v[192:195], v[132:135], v[48:63]
    v_mfma_f32_32x32x16_bf16 v[64:79], v[196:199], v[132:135], v[64:79]
    s_mov_b32 s4, 3
    s_branch L_on2
L_or2:
    buffer_load_dwordx4 v[128:131], v1, s[12:15], s66 offen offset:2048 sc1
    buffer_load_dwordx4 v[132:135], v1, s[12:15], s67 offen offset:2048 sc1
L_on2:
    v_xor_b32 v12, s6, v139
    v_xor_b32 v13, s6, v143
    v_or_b32 v12, v12, v13
    v_cmp_lt_u32 vcc, s5, v12
    s_cmp_lg_u32 s4, 3
    s_cbranch_vccnz L_or3
    s_cbranch_scc1 L_on3
    v_mfma_f32_32x32x16_bf16 v[32:47], v[204:207], v[136:139], v[32:47]
    v_mfma_f32_32x32x16_bf16 v[48:63], v[200:203], v[140:143], v[48:63]
    v_mfma_f32_32x32x16_bf16 v[64:79], v[204:207], v[140:143], v[64:79]
    s_mov_b32 s4, 4
    s_branch L_on3
L_or3:
    buffer_load_dwordx4 v[136:139], v1, s[12:15], s66 offen offset:3072 sc1
    buffer_load_dwordx4 v[140:143], v1, s[12:15], s67 offen offset:3072 sc1
L_on3:
    v_xor_b32 v12, s6, v83
    v_xor_b32 v13, s6, v87
    v_or_b32 v12, v12, v13
    v_cmp_lt_u32 vcc, s5, v12
    s_cmp_lg_u32 s4, 4
    s_cbranch_vccnz L_or4
    s_cbranch_scc1 L_on4
    v_mfma_f32_32x32x16_bf16 v[32:47], v[148:151], v[80:83], v[32:47]
    v_mfma_f32_32x32x16_bf16 v[48:63], v[144:147], v[84:87], v[48:63]
    v_mfma_f32_32x32x16_bf16 v[64:79], v[148:151], v[84:87], v[64:79]
    s_mov_b32 s4, 5
    s_branch L_on4
L_or4:
    buffer_load_dwordx4 v[80:83], v1, s[12:15], s64 offen offset:0 sc1
    buffer_load_dwordx4 v[84:87], v1, s[12:15], s65 offen offset:0 sc1
L_on4:
    v_xor_b32 v12, s6, v91
    v_xor_b32 v13, s6, v95
    v_or_b32 v12, v12, v13
    v_cmp_lt_u32 vcc, s5, v12
    s_cmp_lg_u32 s4, 5
    s_cbranch_vccnz L_or5
    s_cbranch_scc1 L_on5
    v_mfma_f32_32x32x16_bf16 v[32:47], v[156:159], v[88:91], v[32:47]
    v_mfma_f32_32x32x16_bf16 v[48:63], v[152:155], v[92:95], v[48:63]
    v_mfma_f32_32x32x16_bf16 v[64:79], v[156:159], v[92:95], v[64:79]
    s_mov_b32 s4, 6
    s_branch L_on5
L_or5:
    buffer_load_dwordx4 v[88:91], v1, s[12:15], s64 offen offset:1024 sc1
    buffer_load_dwordx4 v[92:95], v1, s[12:15], s65 offen offset:1024 sc1
L_on5:
    v_xor_b32 v12, s6, v99
    v_xor_b32 v13, s6, v103
    v_or_b32 v12, v12, v13
    v_cmp_lt_u32 vcc, s5, v12
    s_cmp_lg_u32 s4, 6
    s_cbranch_vccnz L_or6
    s_cbranch_scc1 L_on6
    v_mfma_f32_32x32x16_bf16 v[32:47], v[164:167], v[96:99], v[32:47]
    v_mfma_f32_32x32x16_bf16 v[48:63], v[160:163], v[100:103], v[48:63]
    v_mfma_f32_32x32x16_bf16 v[64:79], v[164:167], v[100:103], v[64:79]
    s_mov_b32 s4, 7
    s_branch L_on6
L_or6:
    buffer_load_dwordx4 v[96:99], v1, s[12:15], s64 offen offset:2048 sc1
    buffer_load_dwordx4 v[100:103], v1, s[12:15], s65 offen offset:2048 sc1
L_on6:
    v_xor_b32 v12, s6, v107
    v_xor_b32 v13, s6, v111
    v_or_b32 v12, v12, v13
    v_cmp_lt_u32 vcc, s5, v12
    s_cmp_lg_u32 s4, 7
    s_cbranch_vccnz L_or7
    s_cbranch_scc1 L_on7
    v_mfma_f32_32x32x16_bf16 v[32:47], v[172:175], v[104:107], v[32:47]
    v_mfma_f32_32x32x16_bf16 v[48:63], v[168:171], v[108:111], v[48:63]
    v_mfma_f32_32x32x16_bf16 v[64:79], v[172:175], v[108:111], v[64:79]
    s_mov_b32 s4, 8
    s_branch L_od
L_or7:
    buffer_load_dwordx4 v[104:107], v1, s[12:15], s64 offen offset:3072 sc1
    buffer_load_dwordx4 v[108:111], v1, s[12:15], s65 offen offset:3072 sc1
L_on7:
    s_sub_u32 s7, s7, 1
    s_cbranch_scc0 L_or
L_od:
    v_mfma_f32_32x32x16_bf16 v[16:31], v[176:179], v[112:115], v[16:31]
    s_nop 6
    v_mfma_f32_32x32x16_bf16 v[16:31], v[184:187], v[120:123], v[16:31]
    ds_write_b128 v2, v[32:35] offset:0
    ds_write_b128 v2, v[36:39] offset:1024
    v_mfma_f32_32x32x16_bf16 v[16:31], v[192:195], v[128:131], v[16:31]
    ds_write_b128 v2, v[40:43] offset:2048
    ds_write_b128 v2, v[44:47] offset:3072
    v_mfma_f32_32x32x16_bf16 v[16:31], v[200:203], v[136:139], v[16:31]
    ds_write_b128 v2, v[48:51] offset:4096
    ds_write_b128 v2, v[52:55] offset:5120
    v_mfma_f32_32x32x16_bf16 v[16:31], v[144:147], v[80:83], v[16:31]
    ds_write_b128 v2, v[56:59] offset:6144
    ds_write_b128 v2, v[60:63] offset:7168
    v_mfma_f32_32x32x16_bf16 v[16:31], v[152:155], v[88:91], v[16:31]
    ds_write_b128 v2, v[64:67] offset:8192
    ds_write_b128 v2, v[68:71] offset:9216
    v_mfma_f32_32x32x16_bf16 v[16:31], v[160:163], v[96:99], v[16:31]
    ds_write_b128 v2, v[72:75] offset:10240
    ds_write_b128 v2, v[76:79] offset:11264
    v_mfma_f32_32x32x16_bf16 v[16:31], v[168:171], v[104:107], v[16:31]
    s_waitcnt lgkmcnt(0)
    s_barrier
    ds_read_b128 v[96:99], v8 offset:0
    ds_read_b128 v[100:103], v8 offset:1024
    ds_read_b128 v[104:107], v8 offset:2048
    ds_read_b128 v[108:111], v8 offset:3072
    ds_read_b128 v[112:115], v9 offset:4096
    ds_read_b128 v[116:119], v9 offset:5120
    ds_read_b128 v[120:123], v9 offset:6144
    ds_read_b128 v[124:127], v9 offset:7168
    ds_read_b128 v[128:131], v10 offset:8192
    ds_read_b128 v[132:135], v10 offset:9216
    ds_read_b128 v[136:139], v10 offset:10240
    ds_read_b128 v[140:143], v10 offset:11264
    s_waitcnt lgkmcnt(8)
    v_add_f32 v16, v16, v96
    v_add_f32 v17, v17, v97
    v_add_f32 v18, v18, v98
    v_add_f32 v19, v19, v99
    v_add_f32 v20, v20, v100
    v_add_f32 v21, v21, v101
    v_add_f32 v22, v22, v102
    v_add_f32 v23, v23, v103
    v_add_f32 v24, v24, v104
    v_add_f32 v25, v25, v105
    v_add_f32 v26, v26, v106
    v_add_f32 v27, v27, v107
    v_add_f32 v28, v28, v108
    v_add_f32 v29, v29, v109
    v_add_f32 v30, v30, v110
    v_add_f32 v31, v31, v111
    s_waitcnt lgkmcnt(4)
    v_add_f32 v16, v16, v112
    v_add_f32 v17, v17, v113
    v_add_f32 v18, v18, v114
    v_add_f32 v19, v19, v115
    v_add_f32 v20, v20, v116
    v_add_f32 v21, v21, v117
    v_add_f32 v22, v22, v118
    v_add_f32 v23, v23, v119
    v_add_f32 v24, v24, v120
    v_add_f32 v25, v25, v121
    v_add_f32 v26, v26, v122
    v_add_f32 v27, v27, v123
    v_add_f32 v28, v28, v124
    v_add_f32 v29, v29, v125
    v_add_f32 v30, v30, v126
    v_add_f32 v31, v31, v127
    s_waitcnt lgkmcnt(0)
    v_add_f32 v16, v16, v128
    v_add_f32 v17, v17, v129
    v_add_f32 v18, v18, v130
    v_add_f32 v19, v19, v131
    v_add_f32 v20, v20, v132
    v_add_f32 v21, v21, v133
    v_add_f32 v22, v22, v134
    v_add_f32 v23, v23, v135
    v_add_f32 v24, v24, v136
    v_add_f32 v25, v25, v137
    v_add_f32 v26, v26, v138
    v_add_f32 v27, v27, v139
    v_add_f32 v28, v28, v140
    v_add_f32 v29, v29, v141
    v_add_f32 v30, v30, v142
    v_add_f32 v31, v31, v143
    v_cvt_pk_bf16_f32 v80, v16, v17
    v_cvt_pk_bf16_f32 v81, v18, v19
    v_cvt_pk_bf16_f32 v82, v20, v21
    v_cvt_pk_bf16_f32 v83, v22, v23
    v_cvt_pk_bf16_f32 v84, v24, v25
    v_cvt_pk_bf16_f32 v85, v26, v27
    v_cvt_pk_bf16_f32 v86, v28, v29
    v_cvt_pk_bf16_f32 v87, v30, v31
    s_nop 1
    v_permlane32_swap_b32 v80, v82
    v_permlane32_swap_b32 v81, v83
    buffer_store_dwordx4 v[80:83], v11, s[36:39], s74 offen offset:0
    v_permlane32_swap_b32 v84, v86
    v_permlane32_swap_b32 v85, v87
    buffer_store_dwordx4 v[84:87], v11, s[36:39], s74 offen offset:32
    s_branch L_fend
L_idle:
L_fend:
L_end:
    s_endpgm
.section .rodata,"a"
.p2align 6
.amdhsa_kernel gated_mix__grouped_kv_mqa__dense_activation_relu__prompt_kernel
  .amdhsa_next_free_vgpr 256
  .amdhsa_next_free_sgpr 102
  .amdhsa_accum_offset 256
  .amdhsa_group_segment_fixed_size 0
  .amdhsa_kernarg_size 96
  .amdhsa_user_sgpr_count 2
  .amdhsa_user_sgpr_kernarg_segment_ptr 1
  .amdhsa_system_sgpr_workgroup_id_x 1
.end_amdhsa_kernel
```
